```python
import torch

def _softmax(x, axis=-1):
    return torch.softmax(x, dim=axis)
def _gelu(x):
    return torch.nn.functional.gelu(x, approximate="tanh")
def _silu(x):
    return torch.nn.functional.silu(x)
def _sigmoid(x):
    return torch.sigmoid(x)
def _layernorm(x, axis=-1, eps=1e-5):
    m = x.mean(dim=axis, keepdim=True)
    v = x.var(dim=axis, keepdim=True, unbiased=False)
    return (x - m) / torch.sqrt(v + eps)
def _scatter_add(tgt, idx, src, axis=0):
    return tgt.clone().index_add_(axis, idx, src)
def _segment_sum(src, seg, n):
    out = torch.zeros((n,) + src.shape[1:], dtype=src.dtype)
    return out.index_add_(0, seg, src)
def _pad(x, pw):
    flat = tuple(v for pair in reversed(pw) for v in pair)
    return torch.nn.functional.pad(x, flat)

kernel_name = 'sequential_preLN__sliding_block_cached__mixer_token_mlp__decode'

def setup_inputs():

    _w = (lambda a: (lambda t: t.to(torch.bfloat16) if t.is_floating_point() else t)(torch.as_tensor(a)))
    def _A_setup():
        B, Sq, D = 1, 1, 640
        Hq, Hkv, Sk, Dh = 32, 32, 32768, 192
        assert Hq % Hkv == 0, (Hq, Hkv)
        return {
            "x": _w((lambda *s: torch.randn(*s, dtype=torch.bfloat16) * 0.05)(B, Sq, D)),
            "k_cache": _w((lambda *s: torch.randn(*s, dtype=torch.bfloat16) * 1.6)(B, Hkv, Sk, Dh)),
            "v_cache": _w((lambda *s: torch.randn(*s, dtype=torch.bfloat16) * 0.4)(B, Hkv, Sk, Dh)),
            "wq": _w((lambda *s: torch.randn(*s, dtype=torch.bfloat16) * 1.6)(D, Hq * Dh) * (D ** -0.5)),
            "wo": _w((lambda *s: torch.randn(*s, dtype=torch.bfloat16) * 0.4)(Hq * Dh, D) * ((Hq * Dh) ** -0.5)),
        }
    _A_in = _A_setup()

    def _B_setup():
        B, S, D, F = 1, 1, 640, 1536
        return {
            "x": _w((lambda *s: torch.randn(*s, dtype=torch.bfloat16) * 0.05)(B, S, D)),
            "w1": _w((lambda *s: torch.randn(*s, dtype=torch.bfloat16) * 3.2)(S, F) * (S ** -0.5)),
            "b1": _w((lambda *s: torch.randn(*s, dtype=torch.bfloat16) * 1.6)(F) * 0.02),
            "w2": _w((lambda *s: torch.randn(*s, dtype=torch.bfloat16) * 1.6)(F, S) * (F ** -0.5)),
            "b2": _w((lambda *s: torch.randn(*s, dtype=torch.bfloat16) * 1.6)(S) * 0.02),
        }
    _B_in = _B_setup()

    return {
        "A_x": _A_in["x"],
        "A_k_cache": _A_in["k_cache"],
        "A_v_cache": _A_in["v_cache"],
        "A_wq": _A_in["wq"],
        "A_wo": _A_in["wo"],
        "B_x": _B_in["x"],
        "B_w1": _B_in["w1"],
        "B_b1": _B_in["b1"],
        "B_w2": _B_in["w2"],
        "B_b2": _B_in["b2"],
    }

def reference(A_x, A_k_cache, A_v_cache, A_wq, A_wo, B_x, B_w1, B_b1, B_w2, B_b2):
    def _A_ref(x, k_cache, v_cache, wq, wo):
        B, Sq, D = x.shape
        Hq, Dh = 32, 192
        Hkv, Sk = k_cache.shape[1], k_cache.shape[2]
        W = min(4096, max(256, Sk // 4))
        rep = Hq // Hkv
        q = (lambda x, *d: x.permute(*d))((x @ wq).reshape(B, Sq, Hq, Dh), 0, 2, 1, 3)
        k = (lambda x, n, axis: torch.repeat_interleave(x, n, dim=axis))(k_cache[:, :, Sk - W:, :], rep, axis=1)
        v = (lambda x, n, axis: torch.repeat_interleave(x, n, dim=axis))(v_cache[:, :, Sk - W:, :], rep, axis=1)
        scores = torch.einsum("bhqd,bhkd->bhqk", q, k) * (Dh ** -0.5)
        p = _softmax(scores, axis=-1)
        o = torch.einsum("bhqk,bhkd->bhqd", p, v)
        return (lambda x, *d: x.permute(*d))(o, 0, 2, 1, 3).reshape(B, Sq, Hq * Dh) @ wo

    def _B_ref(x, w1, b1, w2, b2):
        B, S, D = x.shape
        h = _layernorm(x, axis=-1)
        u = torch.einsum("bsd,sf->bdf", h, w1) + b1
        u = _gelu(u)
        y = torch.einsum("bdf,fs->bds", u, w2) + b2
        return (lambda x, *d: x.permute(*d))(y, 0, 2, 1)

    x = A_x
    h = x + _A_ref(_layernorm(x, axis=-1), A_k_cache, A_v_cache, A_wq, A_wo)
    h2 = h + _B_ref(_layernorm(h, axis=-1), B_w1, B_b1, B_w2, B_b2)
    return h2
```

```asm
; @launch grid=(256,1,1) block=(512,1,1) lds=98816
.amdgcn_target "amdgcn-amd-amdhsa--gfx950"
.text
.globl sequential_preLN__sliding_block_cached__mixer_token_mlp__decode_kernel
.p2align 8
.type sequential_preLN__sliding_block_cached__mixer_token_mlp__decode_kernel,@function
sequential_preLN__sliding_block_cached__mixer_token_mlp__decode_kernel:
    s_cmp_ge_u32 s2, 256
    s_cbranch_scc1 L_end
    s_load_dwordx2 s[24:25], s[0:1], 24
    s_load_dwordx2 s[32:33], s[0:1], 0
    s_load_dwordx2 s[20:21], s[0:1], 96
    s_getpc_b64 s[96:97]
L_pc:
    s_bfe_u32 s3, s2, 0x20003
    s_lshl_b32 s3, s3, 13
    v_lshlrev_b32 v171, 4, v0
    v_add_u32 v171, s3, v171
    v_min_u32 v171, L_end-L_pc-16, v171
    global_load_dwordx4 v[232:235], v171, s[96:97]
    v_lshrrev_b32 v12, 6, v0
    v_and_b32 v0, 63, v0
    v_readfirstlane_b32 s4, v12
    s_and_b32 s8, s2, 7
    s_lshr_b32 s7, s2, 3
    s_lshr_b32 s5, s7, 3
    s_lshl_b32 s3, s8, 2
    s_add_u32 s5, s5, s3
    s_and_b32 s6, s7, 7
    v_lshrrev_b32 v12, 5, v0
    v_and_b32 v13, 31, v0
    v_mul_u32_u24 v14, 12288, v12
    v_mul_u32_u24 v13, 12, v13
    v_add_u32 v14, v14, v13
    s_mul_i32 s50, s6, 80
    s_mul_i32 s51, s4, 10
    s_add_u32 s51, s50, s51
    s_mul_i32 s50, s51, 12288
    s_mul_i32 s52, s5, 384
    s_add_u32 s50, s50, s52
    s_mov_b32 s26, 7864320
    s_mov_b32 s27, 0x00020000
    s_waitcnt lgkmcnt(0)
    buffer_load_dwordx3 v[124:126], v14, s[24:27], s50 offen nt
    s_add_u32 s50, s50, 24576
    buffer_load_dwordx3 v[128:130], v14, s[24:27], s50 offen nt
    s_add_u32 s50, s50, 24576
    buffer_load_dwordx3 v[132:134], v14, s[24:27], s50 offen nt
    s_add_u32 s50, s50, 24576
    buffer_load_dwordx3 v[136:138], v14, s[24:27], s50 offen nt
    s_add_u32 s50, s50, 24576
    buffer_load_dwordx3 v[140:142], v14, s[24:27], s50 offen nt
    s_load_dword s10, s[20:21], 0
    s_load_dwordx2 s[12:13], s[0:1], 8
    s_load_dwordx8 s[36:43], s[0:1], 48
    s_load_dwordx2 s[16:17], s[0:1], 16
    s_load_dwordx2 s[28:29], s[0:1], 32
    s_load_dwordx2 s[44:45], s[0:1], 80
    s_setprio 3
    s_lshl_b32 s51, s51, 1
    s_mov_b32 s34, 1280
    s_mov_b32 s35, 0x00020000
    v_mul_u32_u24 v13, 20, v0
    v_mov_b32 v12, 0
    buffer_load_dwordx4 v[112:115], v13, s[32:35], 0 offen
    buffer_load_dword v116, v13, s[32:35], 0 offen offset:16
    buffer_load_dwordx4 v[160:163], v12, s[32:35], s51 offen
    buffer_load_dword v164, v12, s[32:35], s51 offen offset:16
    s_mov_b32 s14, 402653184
    s_mov_b32 s15, 0x00020000
    s_mov_b32 s18, 402653184
    s_mov_b32 s19, 0x00020000
    s_mov_b32 s22, 4194304
    s_mov_b32 s23, 0x00020000
    s_mov_b32 s30, 7864320
    s_mov_b32 s31, 0x00020000
    v_and_b32 v1, 15, v0
    v_lshrrev_b32 v2, 4, v0
    s_mul_i32 s46, s5, 12582912
    s_lshl_b32 s52, s6, 9
    s_lshl_b32 s52, s6, 6
    s_lshr_b32 s53, s4, 2
    s_lshl_b32 s53, s53, 11
    s_add_u32 s52, s52, s53
    s_and_b32 s53, s4, 3
    s_lshl_b32 s53, s53, 4
    s_add_u32 s52, s52, s53
    s_add_u32 s52, s52, 28672
    s_mul_i32 s52, s52, 384
    s_add_u32 s46, s46, s52
    s_add_u32 s47, s46, 196608
    s_add_u32 s48, s46, 393216
    s_add_u32 s49, s46, 589824
    v_mul_u32_u24 v3, 1536, v2
    v_lshrrev_b32 v4, 3, v1
    v_cmp_eq_u32 vcc, 0, v4
    v_mul_u32_u24 v4, 384, v4
    v_and_b32 v5, 7, v1
    v_lshl_add_u32 v4, v5, 4, v4
    v_add_u32 v4, v4, v3
    v_add_u32 v4, 256, v4
    v_lshl_add_u32 v3, v1, 4, v3
    s_waitcnt lgkmcnt(0)
    s_cmp_eq_u32 s4, 4
    s_cbranch_scc0 L_nowl
    v_lshlrev_b32 v171, 4, v0
    global_load_dwordx4 v[192:195], v171, s[36:37] offset:0
    global_load_dwordx4 v[204:207], v171, s[38:39] offset:0
    global_load_dwordx4 v[216:219], v171, s[40:41] offset:0
    global_load_dwordx4 v[196:199], v171, s[36:37] offset:1024
    global_load_dwordx4 v[208:211], v171, s[38:39] offset:1024
    global_load_dwordx4 v[220:223], v171, s[40:41] offset:1024
    global_load_dwordx4 v[200:203], v171, s[36:37] offset:2048
    global_load_dwordx4 v[212:215], v171, s[38:39] offset:2048
    global_load_dwordx4 v[224:227], v171, s[40:41] offset:2048
    v_mov_b32 v172, 0
    global_load_ushort v230, v172, s[42:43]
L_nowl:
    s_barrier
    s_cmp_ge_u32 s4, 4
    s_cbranch_scc1 L_c0
    s_setprio 2
    buffer_load_dwordx4 v[16:19], v3, s[12:15], s46 offen offset:0 nt
    buffer_load_dwordx4 v[20:23], v3, s[12:15], s46 offen offset:384 nt
    buffer_load_dwordx4 v[24:27], v3, s[12:15], s46 offen offset:768 nt
    buffer_load_dwordx4 v[28:31], v3, s[12:15], s46 offen offset:1152 nt
    buffer_load_dwordx4 v[32:35], v4, s[12:15], s46 offen offset:0 nt
    buffer_load_dwordx4 v[36:39], v4, s[12:15], s46 offen offset:768 nt
    buffer_load_dwordx4 v[40:43], v3, s[12:15], s47 offen offset:0 nt
    buffer_load_dwordx4 v[44:47], v3, s[12:15], s47 offen offset:384 nt
    buffer_load_dwordx4 v[48:51], v3, s[12:15], s47 offen offset:768 nt
    buffer_load_dwordx4 v[52:55], v3, s[12:15], s47 offen offset:1152 nt
    buffer_load_dwordx4 v[56:59], v4, s[12:15], s47 offen offset:0 nt
    buffer_load_dwordx4 v[60:63], v4, s[12:15], s47 offen offset:768 nt
L_c0:
    v_lshrrev_b32 v6, 3, v1
    v_cmp_eq_u32 vcc, 0, v6
    v_and_b32 v6, 1, v1
    v_and_b32 v5, 7, v1
    v_cndmask_b32 v9, 0, 1.0, vcc
    v_cmp_eq_u32 vcc, 1, v6
    v_mov_b32 v7, 0xffff
    v_mov_b32 v8, 0xffff0000
    v_sub_f32 v10, 1.0, v9
    v_cndmask_b32 v168, v7, v8, vcc
    v_lshrrev_b32 v169, 1, v5
    v_cmp_eq_u32 vcc, 0, v169
    s_nop 1
    v_cndmask_b32 v5, 0, v168, vcc
    v_cmp_eq_u32 vcc, 1, v169
    s_nop 1
    v_cndmask_b32 v6, 0, v168, vcc
    v_cmp_eq_u32 vcc, 2, v169
    s_nop 1
    v_cndmask_b32 v7, 0, v168, vcc
    v_cmp_eq_u32 vcc, 3, v169
    s_nop 1
    v_cndmask_b32 v8, 0, v168, vcc
    v_mov_b32 v15, 0xfffffe00
    v_and_b32 v171, 31, v0
    v_lshlrev_b32 v231, 4, v171
    s_lshl_b32 s94, s8, 9
    s_add_u32 s94, s94, 32768
L_warm_begin:
    s_cmp_lt_u32 s4, 4
    s_cbranch_scc1 L_qw_old
    s_cmp_eq_u32 s4, 4
    s_cbranch_scc1 L_qw_4
    s_waitcnt vmcnt(0)
    s_branch L_qw_go
L_qw_4:
    s_waitcnt vmcnt(10)
    s_branch L_qw_go
L_qw_old:
    s_waitcnt vmcnt(12)
L_qw_go:
    v_lshlrev_b32 v144, 16, v112
    v_and_b32 v145, 0xffff0000, v112
    v_lshlrev_b32 v146, 16, v113
    v_and_b32 v147, 0xffff0000, v113
    v_lshlrev_b32 v148, 16, v114
    v_and_b32 v149, 0xffff0000, v114
    v_lshlrev_b32 v150, 16, v115
    v_and_b32 v151, 0xffff0000, v115
    v_lshlrev_b32 v152, 16, v116
    v_and_b32 v153, 0xffff0000, v116
    s_cmp_eq_u32 s4, 6
    s_cbranch_scc0 L_noxs
    v_mul_u32_u24 v171, 40, v0
    ds_write_b64 v171, v[144:145] offset:9984
    ds_write_b64 v171, v[146:147] offset:9992
    ds_write_b64 v171, v[148:149] offset:10000
    ds_write_b64 v171, v[150:151] offset:10008
    ds_write_b64 v171, v[152:153] offset:10016
L_noxs:
    s_cmp_eq_u32 s4, 5
    s_cbranch_scc0 L_noinit
    v_mov_b32 v172, 0
    v_mov_b32 v173, 0
    v_mov_b32 v174, 0
    v_mov_b32 v175, 0
    v_lshlrev_b32 v171, 4, v0
    ds_write_b128 v171, v[172:175] offset:8832
    v_lshlrev_b32 v171, 2, v0
    ds_write_b32 v171, v172 offset:8704
    v_mov_b32 v173, -1
    s_mov_b64 exec, 0xff
    ds_write_b32 v171, v173 offset:8768
    s_mov_b64 exec, -1
L_noinit:
    v_add_f32 v168, v144, v145
    v_add_f32 v171, v146, v147
    v_add_f32 v172, v148, v149
    v_add_f32 v173, v150, v151
    v_add_f32 v174, v152, v153
    v_add_f32 v168, v168, v171
    v_add_f32 v172, v172, v173
    v_add_f32 v168, v168, v174
    v_add_f32 v168, v168, v172
    s_nop 1
    v_add_f32_dpp v168, v168, v168 row_ror:8 row_mask:0xf bank_mask:0xf
    s_nop 1
    v_add_f32_dpp v168, v168, v168 row_ror:4 row_mask:0xf bank_mask:0xf
    s_nop 1
    v_add_f32_dpp v168, v168, v168 row_ror:2 row_mask:0xf bank_mask:0xf
    s_nop 1
    v_add_f32_dpp v168, v168, v168 row_ror:1 row_mask:0xf bank_mask:0xf
    v_mov_b32 v171, v168
    s_nop 1
    v_permlane16_swap_b32 v168, v171
    v_add_f32 v168, v168, v171
    v_mov_b32 v171, v168
    s_nop 1
    v_permlane32_swap_b32 v168, v171
    v_add_f32 v168, v168, v171
    v_mul_f32 v168, 0x3acccccd, v168
    v_sub_f32 v171, v144, v168
    v_mul_f32 v169, v171, v171
    v_sub_f32 v172, v145, v168
    v_mul_f32 v170, v172, v172
    v_sub_f32 v171, v146, v168
    v_fmac_f32 v169, v171, v171
    v_sub_f32 v172, v147, v168
    v_fmac_f32 v170, v172, v172
    v_sub_f32 v171, v148, v168
    v_fmac_f32 v169, v171, v171
    v_sub_f32 v172, v149, v168
    v_fmac_f32 v170, v172, v172
    v_sub_f32 v171, v150, v168
    v_fmac_f32 v169, v171, v171
    v_sub_f32 v172, v151, v168
    v_fmac_f32 v170, v172, v172
    v_sub_f32 v171, v152, v168
    v_fmac_f32 v169, v171, v171
    v_sub_f32 v172, v153, v168
    v_fmac_f32 v170, v172, v172
    v_add_f32 v169, v169, v170
    s_nop 1
    v_add_f32_dpp v169, v169, v169 row_ror:8 row_mask:0xf bank_mask:0xf
    s_nop 1
    v_add_f32_dpp v169, v169, v169 row_ror:4 row_mask:0xf bank_mask:0xf
    s_nop 1
    v_add_f32_dpp v169, v169, v169 row_ror:2 row_mask:0xf bank_mask:0xf
    s_nop 1
    v_add_f32_dpp v169, v169, v169 row_ror:1 row_mask:0xf bank_mask:0xf
    v_mov_b32 v171, v169
    s_nop 1
    v_permlane16_swap_b32 v169, v171
    v_add_f32 v169, v169, v171
    v_mov_b32 v171, v169
    s_nop 1
    v_permlane32_swap_b32 v169, v171
    v_add_f32 v169, v169, v171
    v_mul_f32 v169, 0x3acccccd, v169
    v_cvt_pk_bf16_f32 v171, v168, v169
    v_lshlrev_b32 v168, 16, v171
    v_and_b32 v169, 0xffff0000, v171
    v_add_f32 v169, 0x3727c5ac, v169
    v_cvt_pk_bf16_f32 v171, v169, v169
    v_lshlrev_b32 v169, 16, v171
    v_sqrt_f32 v169, v169
    s_nop 0
    v_cvt_pk_bf16_f32 v171, v169, v169
    v_lshlrev_b32 v169, 16, v171
    v_rcp_f32 v170, v169
    s_mov_b32 s54, 0
    s_mov_b32 s55, -1
    v_lshlrev_b32 v171, 16, v160
    v_and_b32 v172, 0xffff0000, v160
    v_cndmask_b32 v117, v171, v172, s[54:55]
    v_lshlrev_b32 v171, 16, v161
    v_and_b32 v172, 0xffff0000, v161
    v_cndmask_b32 v118, v171, v172, s[54:55]
    v_lshlrev_b32 v171, 16, v162
    v_and_b32 v172, 0xffff0000, v162
    v_cndmask_b32 v119, v171, v172, s[54:55]
    v_lshlrev_b32 v171, 16, v163
    v_and_b32 v172, 0xffff0000, v163
    v_cndmask_b32 v120, v171, v172, s[54:55]
    v_lshlrev_b32 v171, 16, v164
    v_and_b32 v172, 0xffff0000, v164
    v_cndmask_b32 v121, v171, v172, s[54:55]
    v_sub_f32 v117, v117, v168
    v_sub_f32 v118, v118, v168
    v_sub_f32 v119, v119, v168
    v_sub_f32 v120, v120, v168
    v_sub_f32 v121, v121, v168
    v_cvt_pk_bf16_f32 v171, v117, v118
    v_lshlrev_b32 v117, 16, v171
    v_and_b32 v118, 0xffff0000, v171
    v_cvt_pk_bf16_f32 v172, v119, v120
    v_lshlrev_b32 v119, 16, v172
    v_and_b32 v120, 0xffff0000, v172
    v_cvt_pk_bf16_f32 v173, v121, v121
    v_lshlrev_b32 v121, 16, v173
    v_mul_f32 v117, v117, v170
    v_mul_f32 v118, v118, v170
    v_mul_f32 v119, v119, v170
    v_mul_f32 v120, v120, v170
    v_mul_f32 v121, v121, v170
    v_cvt_pk_bf16_f32 v171, v117, v118
    v_lshlrev_b32 v117, 16, v171
    v_and_b32 v118, 0xffff0000, v171
    v_cvt_pk_bf16_f32 v172, v119, v120
    v_lshlrev_b32 v119, 16, v172
    v_and_b32 v120, 0xffff0000, v172
    v_cvt_pk_bf16_f32 v173, v121, v121
    v_lshlrev_b32 v121, 16, v173
    v_lshlrev_b32 v171, 16, v124
    v_and_b32 v172, 0xffff0000, v124
    v_mul_f32 v154, v171, v117
    v_mul_f32 v155, v172, v117
    v_lshlrev_b32 v171, 16, v125
    v_and_b32 v172, 0xffff0000, v125
    v_mul_f32 v156, v171, v117
    v_mul_f32 v157, v172, v117
    v_lshlrev_b32 v171, 16, v126
    v_and_b32 v172, 0xffff0000, v126
    v_mul_f32 v158, v171, v117
    v_mul_f32 v159, v172, v117
    v_lshlrev_b32 v171, 16, v128
    v_and_b32 v172, 0xffff0000, v128
    v_fmac_f32 v154, v171, v118
    v_fmac_f32 v155, v172, v118
    v_lshlrev_b32 v171, 16, v129
    v_and_b32 v172, 0xffff0000, v129
    v_fmac_f32 v156, v171, v118
    v_fmac_f32 v157, v172, v118
    v_lshlrev_b32 v171, 16, v130
    v_and_b32 v172, 0xffff0000, v130
    v_fmac_f32 v158, v171, v118
    v_fmac_f32 v159, v172, v118
    v_lshlrev_b32 v171, 16, v132
    v_and_b32 v172, 0xffff0000, v132
    v_fmac_f32 v154, v171, v119
    v_fmac_f32 v155, v172, v119
    v_lshlrev_b32 v171, 16, v133
    v_and_b32 v172, 0xffff0000, v133
    v_fmac_f32 v156, v171, v119
    v_fmac_f32 v157, v172, v119
    v_lshlrev_b32 v171, 16, v134
    v_and_b32 v172, 0xffff0000, v134
    v_fmac_f32 v158, v171, v119
    v_fmac_f32 v159, v172, v119
    v_lshlrev_b32 v171, 16, v136
    v_and_b32 v172, 0xffff0000, v136
    v_fmac_f32 v154, v171, v120
    v_fmac_f32 v155, v172, v120
    v_lshlrev_b32 v171, 16, v137
    v_and_b32 v172, 0xffff0000, v137
    v_fmac_f32 v156, v171, v120
    v_fmac_f32 v157, v172, v120
    v_lshlrev_b32 v171, 16, v138
    v_and_b32 v172, 0xffff0000, v138
    v_fmac_f32 v158, v171, v120
    v_fmac_f32 v159, v172, v120
    v_lshlrev_b32 v171, 16, v140
    v_and_b32 v172, 0xffff0000, v140
    v_fmac_f32 v154, v171, v121
    v_fmac_f32 v155, v172, v121
    v_lshlrev_b32 v171, 16, v141
    v_and_b32 v172, 0xffff0000, v141
    v_fmac_f32 v156, v171, v121
    v_fmac_f32 v157, v172, v121
    v_lshlrev_b32 v171, 16, v142
    v_and_b32 v172, 0xffff0000, v142
    v_fmac_f32 v158, v171, v121
    v_fmac_f32 v159, v172, v121
    v_mov_b32 v171, v154
    v_mov_b32 v172, v155
    v_mov_b32 v173, v156
    v_mov_b32 v174, v157
    v_mov_b32 v175, v158
    v_mov_b32 v176, v159
    v_permlane32_swap_b32 v154, v171
    v_permlane32_swap_b32 v155, v172
    v_permlane32_swap_b32 v156, v173
    v_permlane32_swap_b32 v157, v174
    v_permlane32_swap_b32 v158, v175
    v_permlane32_swap_b32 v159, v176
    v_add_f32 v154, v154, v171
    v_add_f32 v155, v155, v172
    v_add_f32 v156, v156, v173
    v_add_f32 v157, v157, v174
    v_add_f32 v158, v158, v175
    v_add_f32 v159, v159, v176
    v_and_b32 v171, 31, v0
    v_mul_u32_u24 v171, 24, v171
    s_mul_i32 s52, s4, 768
    v_add_u32 v171, s52, v171
    ds_write_b64 v171, v[154:155] offset:0
    ds_write_b64 v171, v[156:157] offset:8
    ds_write_b64 v171, v[158:159] offset:16
    s_cmp_eq_u32 s4, 6
    s_cbranch_scc0 L_noxdp
    s_waitcnt lgkmcnt(0)
    s_add_u32 s92, s10, 1
    s_and_b32 s9, s92, 511
    s_getreg_b32 s93, hwreg(HW_REG_XCC_ID, 0, 4)
    s_add_u32 s52, s93, 1
    s_lshl_b32 s52, s52, 16
    s_or_b32 s52, s52, s9
    s_lshl_b32 s53, s8, 5
    s_add_u32 s53, s53, s7
    s_lshl_b32 s53, s53, 4
    s_add_u32 s53, s53, 32768
    v_mov_b32 v168, s52
    v_mov_b32 v169, s52
    v_mov_b32 v170, s52
    v_mov_b32 v171, s52
    v_mov_b32 v172, 0
    s_mov_b64 exec, 1
    buffer_store_dwordx4 v[168:171], v172, s[20:23], s53 offen sc1
    s_mov_b64 exec, -1
L_noxdp:
    s_cmp_eq_u32 s4, 4
    s_cbranch_scc0 L_now2l
    s_waitcnt vmcnt(0)
    v_lshlrev_b32 v171, 4, v0
    ds_write_b128 v171, v[192:195] offset:16384
    ds_write_b128 v171, v[204:207] offset:19456
    ds_write_b128 v171, v[216:219] offset:22528
    ds_write_b128 v171, v[196:199] offset:17408
    ds_write_b128 v171, v[208:211] offset:20480
    ds_write_b128 v171, v[220:223] offset:23552
    ds_write_b128 v171, v[200:203] offset:18432
    ds_write_b128 v171, v[212:215] offset:21504
    ds_write_b128 v171, v[224:227] offset:24576
    v_lshlrev_b32 v230, 16, v230
    v_mov_b32 v172, 0
    ds_write_b32 v172, v230 offset:25600
L_now2l:
    s_waitcnt lgkmcnt(0)
    s_barrier
    s_add_u32 s92, s10, 1
    s_and_b32 s9, s92, 511
    s_mov_b32 s61, 0
    v_mov_b32 v236, 0
    v_mov_b32 v238, 0
    s_cmp_lt_u32 s4, 4
    s_cbranch_scc1 L_kold
    s_cmp_eq_u32 s4, 7
    s_cbranch_scc1 L_w7
    s_setprio 0
    v_lshlrev_b32 v171, 4, v0
    v_mov_b32 v172, 0
    ds_read_b128 v[192:195], v171 offset:16384
    ds_read_b128 v[204:207], v171 offset:19456
    ds_read_b128 v[216:219], v171 offset:22528
    ds_read_b128 v[196:199], v171 offset:17408
    ds_read_b128 v[208:211], v171 offset:20480
    ds_read_b128 v[220:223], v171 offset:23552
    ds_read_b128 v[200:203], v171 offset:18432
    ds_read_b128 v[212:215], v171 offset:21504
    ds_read_b128 v[224:227], v171 offset:24576
    ds_read_b32 v230, v172 offset:25600
    s_waitcnt lgkmcnt(0)
    s_mov_b32 s54, 0xbdd2d3e8
    s_mov_b32 s55, 0xbdd2d3e8
    s_mov_b32 s56, 1.0
    s_mov_b32 s57, 1.0
    v_mov_b32 v12, 0xc0135761
    v_mov_b32 v13, 0xc0135761
    s_sub_u32 s59, s4, 4
    s_mul_i32 s59, s59, 2
    s_add_u32 s60, s59, 2
L_te:
    s_lshl_b32 s52, s2, 4
    s_add_u32 s52, s52, s59
    s_lshr_b32 s53, s52, 11
    s_lshl_b32 s53, s53, 31
    s_and_b32 s52, s52, 2047
    s_add_u32 s52, s52, 14592
    s_lshl_b32 s52, s52, 16
    s_or_b32 s50, s52, s53
    s_mov_b32 s51, s50
    s_call_b64 s[62:63], L_entry
    s_and_b32 s52, s92, 0xffff
    v_or_b32 v168, s52, v168
    v_mov_b32 v169, s92
    s_lshl_b32 s52, s2, 4
    s_add_u32 s52, s52, s59
    s_lshl_b32 s52, s52, 3
    s_add_u32 s52, s52, 1335296
    v_mov_b32 v170, 0
    s_mov_b64 exec, 1
    buffer_store_dwordx2 v[168:169], v170, s[20:23], s52 offen sc1
    s_mov_b64 exec, -1
    s_add_u32 s59, s59, 1
    s_cmp_lt_u32 s59, s60
    s_cbranch_scc1 L_te
    s_branch L_k01
L_w7:
    s_mov_b32 exec_lo, -1
    s_mov_b32 exec_hi, 0xffff
    v_lshlrev_b32 v171, 4, v0
    ds_read_b128 v[64:67], v171 offset:0
    ds_read_b128 v[68:71], v171 offset:768
    ds_read_b128 v[72:75], v171 offset:1536
    ds_read_b128 v[76:79], v171 offset:2304
    ds_read_b128 v[80:83], v171 offset:3072
    ds_read_b128 v[84:87], v171 offset:3840
    ds_read_b128 v[88:91], v171 offset:4608
    ds_read_b128 v[92:95], v171 offset:5376
    s_lshl_b32 s52, s5, 3
    s_add_u32 s53, s52, s6
    s_mul_i32 s53, s53, 768
    s_add_u32 s53, s53, 65536
    s_waitcnt lgkmcnt(0)
    v_add_f32 v64, v64, v68
    v_add_f32 v72, v72, v76
    v_add_f32 v80, v80, v84
    v_add_f32 v88, v88, v92
    v_add_f32 v65, v65, v69
    v_add_f32 v73, v73, v77
    v_add_f32 v81, v81, v85
    v_add_f32 v89, v89, v93
    v_add_f32 v66, v66, v70
    v_add_f32 v74, v74, v78
    v_add_f32 v82, v82, v86
    v_add_f32 v90, v90, v94
    v_add_f32 v67, v67, v71
    v_add_f32 v75, v75, v79
    v_add_f32 v83, v83, v87
    v_add_f32 v91, v91, v95
    v_add_f32 v64, v64, v72
    v_add_f32 v80, v80, v88
    v_add_f32 v65, v65, v73
    v_add_f32 v81, v81, v89
    v_add_f32 v66, v66, v74
    v_add_f32 v82, v82, v90
    v_add_f32 v67, v67, v75
    v_add_f32 v83, v83, v91
    v_add_f32 v176, v64, v80
    v_add_f32 v177, v65, v81
    v_add_f32 v178, v66, v82
    v_add_f32 v179, v67, v83
    v_and_or_b32 v176, v176, v15, s9
    v_and_or_b32 v177, v177, v15, s9
    v_and_or_b32 v178, v178, v15, s9
    v_and_or_b32 v179, v179, v15, s9
    buffer_store_dwordx4 v[176:179], v171, s[20:23], s53 offen
    s_add_u32 s95, s53, 1310720
    buffer_store_dwordx4 v[176:179], v171, s[20:23], s95 offen sc1
    s_mul_i32 s52, s52, 768
    s_add_u32 s52, s52, 65536
    s_add_u32 s53, s52, 3072
    s_sleep 14
    buffer_load_dwordx4 v[16:19], v171, s[20:23], s52 offen offset:0 sc1
    buffer_load_dwordx4 v[20:23], v171, s[20:23], s52 offen offset:768 sc1
    buffer_load_dwordx4 v[24:27], v171, s[20:23], s52 offen offset:1536 sc1
    buffer_load_dwordx4 v[28:31], v171, s[20:23], s52 offen offset:2304 sc1
    buffer_load_dwordx4 v[32:35], v171, s[20:23], s53 offen offset:0 sc1
    buffer_load_dwordx4 v[36:39], v171, s[20:23], s53 offen offset:768 sc1
    buffer_load_dwordx4 v[40:43], v171, s[20:23], s53 offen offset:1536 sc1
    buffer_load_dwordx4 v[44:47], v171, s[20:23], s53 offen offset:2304 sc1
    s_sleep 14
    buffer_load_dwordx4 v[48:51], v171, s[20:23], s52 offen offset:0 sc1
    buffer_load_dwordx4 v[52:55], v171, s[20:23], s52 offen offset:768 sc1
    buffer_load_dwordx4 v[56:59], v171, s[20:23], s52 offen offset:1536 sc1
    buffer_load_dwordx4 v[60:63], v171, s[20:23], s52 offen offset:2304 sc1
    buffer_load_dwordx4 v[64:67], v171, s[20:23], s53 offen offset:0 sc1
    buffer_load_dwordx4 v[68:71], v171, s[20:23], s53 offen offset:768 sc1
    buffer_load_dwordx4 v[72:75], v171, s[20:23], s53 offen offset:1536 sc1
    buffer_load_dwordx4 v[76:79], v171, s[20:23], s53 offen offset:2304 sc1
    s_sleep 14
    buffer_load_dwordx4 v[80:83], v171, s[20:23], s52 offen offset:0 sc1
    buffer_load_dwordx4 v[84:87], v171, s[20:23], s52 offen offset:768 sc1
    buffer_load_dwordx4 v[88:91], v171, s[20:23], s52 offen offset:1536 sc1
    buffer_load_dwordx4 v[92:95], v171, s[20:23], s52 offen offset:2304 sc1
    buffer_load_dwordx4 v[96:99], v171, s[20:23], s53 offen offset:0 sc1
    buffer_load_dwordx4 v[100:103], v171, s[20:23], s53 offen offset:768 sc1
    buffer_load_dwordx4 v[104:107], v171, s[20:23], s53 offen offset:1536 sc1
    buffer_load_dwordx4 v[108:111], v171, s[20:23], s53 offen offset:2304 sc1
    s_mov_b32 s58, 0
L_qp:
    s_waitcnt vmcnt(16)
    v_bitop3_b32 v172, v16, v17, s9 bitop3:0x7e
    v_bitop3_b32 v173, v18, v19, s9 bitop3:0x7e
    v_or_b32 v172, v172, v173
    v_bitop3_b32 v173, v20, v21, s9 bitop3:0x7e
    v_bitop3_b32 v14, v22, v23, s9 bitop3:0x7e
    v_or3_b32 v172, v172, v173, v14
    v_bitop3_b32 v173, v24, v25, s9 bitop3:0x7e
    v_bitop3_b32 v14, v26, v27, s9 bitop3:0x7e
    v_or3_b32 v172, v172, v173, v14
    v_bitop3_b32 v173, v28, v29, s9 bitop3:0x7e
    v_bitop3_b32 v14, v30, v31, s9 bitop3:0x7e
    v_or3_b32 v172, v172, v173, v14
    v_bitop3_b32 v173, v32, v33, s9 bitop3:0x7e
    v_bitop3_b32 v14, v34, v35, s9 bitop3:0x7e
    v_or3_b32 v172, v172, v173, v14
    v_bitop3_b32 v173, v36, v37, s9 bitop3:0x7e
    v_bitop3_b32 v14, v38, v39, s9 bitop3:0x7e
    v_or3_b32 v172, v172, v173, v14
    v_bitop3_b32 v173, v40, v41, s9 bitop3:0x7e
    v_bitop3_b32 v14, v42, v43, s9 bitop3:0x7e
    v_or3_b32 v172, v172, v173, v14
    v_bitop3_b32 v173, v44, v45, s9 bitop3:0x7e
    v_bitop3_b32 v14, v46, v47, s9 bitop3:0x7e
    v_or3_b32 v172, v172, v173, v14
    v_bitop3_b32 v172, v172, v172, v15 bitop3:0x50
    v_cmp_ne_u32 vcc, 0, v172
    s_cbranch_vccz L_qp_ok0
    buffer_load_dwordx4 v[16:19], v171, s[20:23], s52 offen offset:0 sc1
    buffer_load_dwordx4 v[20:23], v171, s[20:23], s52 offen offset:768 sc1
    buffer_load_dwordx4 v[24:27], v171, s[20:23], s52 offen offset:1536 sc1
    buffer_load_dwordx4 v[28:31], v171, s[20:23], s52 offen offset:2304 sc1
    buffer_load_dwordx4 v[32:35], v171, s[20:23], s53 offen offset:0 sc1
    buffer_load_dwordx4 v[36:39], v171, s[20:23], s53 offen offset:768 sc1
    buffer_load_dwordx4 v[40:43], v171, s[20:23], s53 offen offset:1536 sc1
    buffer_load_dwordx4 v[44:47], v171, s[20:23], s53 offen offset:2304 sc1
    s_waitcnt vmcnt(16)
    v_bitop3_b32 v172, v48, v49, s9 bitop3:0x7e
    v_bitop3_b32 v173, v50, v51, s9 bitop3:0x7e
    v_or_b32 v172, v172, v173
    v_bitop3_b32 v173, v52, v53, s9 bitop3:0x7e
    v_bitop3_b32 v14, v54, v55, s9 bitop3:0x7e
    v_or3_b32 v172, v172, v173, v14
    v_bitop3_b32 v173, v56, v57, s9 bitop3:0x7e
    v_bitop3_b32 v14, v58, v59, s9 bitop3:0x7e
    v_or3_b32 v172, v172, v173, v14
    v_bitop3_b32 v173, v60, v61, s9 bitop3:0x7e
    v_bitop3_b32 v14, v62, v63, s9 bitop3:0x7e
    v_or3_b32 v172, v172, v173, v14
    v_bitop3_b32 v173, v64, v65, s9 bitop3:0x7e
    v_bitop3_b32 v14, v66, v67, s9 bitop3:0x7e
    v_or3_b32 v172, v172, v173, v14
    v_bitop3_b32 v173, v68, v69, s9 bitop3:0x7e
    v_bitop3_b32 v14, v70, v71, s9 bitop3:0x7e
    v_or3_b32 v172, v172, v173, v14
    v_bitop3_b32 v173, v72, v73, s9 bitop3:0x7e
    v_bitop3_b32 v14, v74, v75, s9 bitop3:0x7e
    v_or3_b32 v172, v172, v173, v14
    v_bitop3_b32 v173, v76, v77, s9 bitop3:0x7e
    v_bitop3_b32 v14, v78, v79, s9 bitop3:0x7e
    v_or3_b32 v172, v172, v173, v14
    v_bitop3_b32 v172, v172, v172, v15 bitop3:0x50
    v_cmp_ne_u32 vcc, 0, v172
    s_cbranch_vccz L_qp_ok1
    buffer_load_dwordx4 v[48:51], v171, s[20:23], s52 offen offset:0 sc1
    buffer_load_dwordx4 v[52:55], v171, s[20:23], s52 offen offset:768 sc1
    buffer_load_dwordx4 v[56:59], v171, s[20:23], s52 offen offset:1536 sc1
    buffer_load_dwordx4 v[60:63], v171, s[20:23], s52 offen offset:2304 sc1
    buffer_load_dwordx4 v[64:67], v171, s[20:23], s53 offen offset:0 sc1
    buffer_load_dwordx4 v[68:71], v171, s[20:23], s53 offen offset:768 sc1
    buffer_load_dwordx4 v[72:75], v171, s[20:23], s53 offen offset:1536 sc1
    buffer_load_dwordx4 v[76:79], v171, s[20:23], s53 offen offset:2304 sc1
    s_waitcnt vmcnt(16)
    v_bitop3_b32 v172, v80, v81, s9 bitop3:0x7e
    v_bitop3_b32 v173, v82, v83, s9 bitop3:0x7e
    v_or_b32 v172, v172, v173
    v_bitop3_b32 v173, v84, v85, s9 bitop3:0x7e
    v_bitop3_b32 v14, v86, v87, s9 bitop3:0x7e
    v_or3_b32 v172, v172, v173, v14
    v_bitop3_b32 v173, v88, v89, s9 bitop3:0x7e
    v_bitop3_b32 v14, v90, v91, s9 bitop3:0x7e
    v_or3_b32 v172, v172, v173, v14
    v_bitop3_b32 v173, v92, v93, s9 bitop3:0x7e
    v_bitop3_b32 v14, v94, v95, s9 bitop3:0x7e
    v_or3_b32 v172, v172, v173, v14
    v_bitop3_b32 v173, v96, v97, s9 bitop3:0x7e
    v_bitop3_b32 v14, v98, v99, s9 bitop3:0x7e
    v_or3_b32 v172, v172, v173, v14
    v_bitop3_b32 v173, v100, v101, s9 bitop3:0x7e
    v_bitop3_b32 v14, v102, v103, s9 bitop3:0x7e
    v_or3_b32 v172, v172, v173, v14
    v_bitop3_b32 v173, v104, v105, s9 bitop3:0x7e
    v_bitop3_b32 v14, v106, v107, s9 bitop3:0x7e
    v_or3_b32 v172, v172, v173, v14
    v_bitop3_b32 v173, v108, v109, s9 bitop3:0x7e
    v_bitop3_b32 v14, v110, v111, s9 bitop3:0x7e
    v_or3_b32 v172, v172, v173, v14
    v_bitop3_b32 v172, v172, v172, v15 bitop3:0x50
    v_cmp_ne_u32 vcc, 0, v172
    s_cbranch_vccz L_qp_ok2
    buffer_load_dwordx4 v[80:83], v171, s[20:23], s52 offen offset:0 sc1
    buffer_load_dwordx4 v[84:87], v171, s[20:23], s52 offen offset:768 sc1
    buffer_load_dwordx4 v[88:91], v171, s[20:23], s52 offen offset:1536 sc1
    buffer_load_dwordx4 v[92:95], v171, s[20:23], s52 offen offset:2304 sc1
    buffer_load_dwordx4 v[96:99], v171, s[20:23], s53 offen offset:0 sc1
    buffer_load_dwordx4 v[100:103], v171, s[20:23], s53 offen offset:768 sc1
    buffer_load_dwordx4 v[104:107], v171, s[20:23], s53 offen offset:1536 sc1
    buffer_load_dwordx4 v[108:111], v171, s[20:23], s53 offen offset:2304 sc1
    s_add_u32 s58, s58, 1
    s_cmp_eq_u32 s58, 2
    s_cbranch_scc0 L_qp_same
    s_add_u32 s52, s52, 1310720
    s_add_u32 s53, s53, 1310720
L_qp_same:
    s_cmp_lt_u32 s58, 32768
    s_cbranch_scc1 L_qp
L_qp_ok0:
    v_add_f32 v16, v16, v20
    v_add_f32 v24, v24, v28
    v_add_f32 v32, v32, v36
    v_add_f32 v40, v40, v44
    v_add_f32 v17, v17, v21
    v_add_f32 v25, v25, v29
    v_add_f32 v33, v33, v37
    v_add_f32 v41, v41, v45
    v_add_f32 v18, v18, v22
    v_add_f32 v26, v26, v30
    v_add_f32 v34, v34, v38
    v_add_f32 v42, v42, v46
    v_add_f32 v19, v19, v23
    v_add_f32 v27, v27, v31
    v_add_f32 v35, v35, v39
    v_add_f32 v43, v43, v47
    v_add_f32 v16, v16, v24
    v_add_f32 v32, v32, v40
    v_add_f32 v17, v17, v25
    v_add_f32 v33, v33, v41
    v_add_f32 v18, v18, v26
    v_add_f32 v34, v34, v42
    v_add_f32 v19, v19, v27
    v_add_f32 v35, v35, v43
    v_add_f32 v176, v16, v32
    v_add_f32 v177, v17, v33
    v_add_f32 v178, v18, v34
    v_add_f32 v179, v19, v35
    s_branch L_qp_done
L_qp_ok1:
    v_add_f32 v48, v48, v52
    v_add_f32 v56, v56, v60
    v_add_f32 v64, v64, v68
    v_add_f32 v72, v72, v76
    v_add_f32 v49, v49, v53
    v_add_f32 v57, v57, v61
    v_add_f32 v65, v65, v69
    v_add_f32 v73, v73, v77
    v_add_f32 v50, v50, v54
    v_add_f32 v58, v58, v62
    v_add_f32 v66, v66, v70
    v_add_f32 v74, v74, v78
    v_add_f32 v51, v51, v55
    v_add_f32 v59, v59, v63
    v_add_f32 v67, v67, v71
    v_add_f32 v75, v75, v79
    v_add_f32 v48, v48, v56
    v_add_f32 v64, v64, v72
    v_add_f32 v49, v49, v57
    v_add_f32 v65, v65, v73
    v_add_f32 v50, v50, v58
    v_add_f32 v66, v66, v74
    v_add_f32 v51, v51, v59
    v_add_f32 v67, v67, v75
    v_add_f32 v176, v48, v64
    v_add_f32 v177, v49, v65
    v_add_f32 v178, v50, v66
    v_add_f32 v179, v51, v67
    s_branch L_qp_done
L_qp_ok2:
    v_add_f32 v80, v80, v84
    v_add_f32 v88, v88, v92
    v_add_f32 v96, v96, v100
    v_add_f32 v104, v104, v108
    v_add_f32 v81, v81, v85
    v_add_f32 v89, v89, v93
    v_add_f32 v97, v97, v101
    v_add_f32 v105, v105, v109
    v_add_f32 v82, v82, v86
    v_add_f32 v90, v90, v94
    v_add_f32 v98, v98, v102
    v_add_f32 v106, v106, v110
    v_add_f32 v83, v83, v87
    v_add_f32 v91, v91, v95
    v_add_f32 v99, v99, v103
    v_add_f32 v107, v107, v111
    v_add_f32 v80, v80, v88
    v_add_f32 v96, v96, v104
    v_add_f32 v81, v81, v89
    v_add_f32 v97, v97, v105
    v_add_f32 v82, v82, v90
    v_add_f32 v98, v98, v106
    v_add_f32 v83, v83, v91
    v_add_f32 v99, v99, v107
    v_add_f32 v176, v80, v96
    v_add_f32 v177, v81, v97
    v_add_f32 v178, v82, v98
    v_add_f32 v179, v83, v99
L_qp_done:
    v_cvt_pk_bf16_f32 v176, v176, v177
    v_cvt_pk_bf16_f32 v177, v178, v179
    v_lshlrev_b32 v171, 3, v0
    ds_write_b64 v171, v[176:177] offset:8192
    v_mov_b32 v172, 0
    v_mov_b32 v173, 1
    s_waitcnt lgkmcnt(0)
    ds_write_b32 v172, v173 offset:8704
    s_mov_b64 exec, -1
    v_lshlrev_b32 v171, 4, v0
    v_mov_b32 v172, 0
    ds_read_b128 v[192:195], v171 offset:16384
    ds_read_b128 v[204:207], v171 offset:19456
    ds_read_b128 v[216:219], v171 offset:22528
    ds_read_b128 v[196:199], v171 offset:17408
    ds_read_b128 v[208:211], v171 offset:20480
    ds_read_b128 v[220:223], v171 offset:23552
    ds_read_b128 v[200:203], v171 offset:18432
    ds_read_b128 v[212:215], v171 offset:21504
    ds_read_b128 v[224:227], v171 offset:24576
    ds_read_b32 v230, v172 offset:25600
    s_waitcnt lgkmcnt(0)
L_k01:
    s_setprio 2
    s_cmp_eq_u32 s4, 6
    s_cbranch_scc0 L_noxdl
    buffer_load_dwordx4 v[184:187], v231, s[20:23], s94 offen sc1
L_noxdl:
    s_waitcnt vmcnt(4)
    buffer_load_dwordx4 v[16:19], v3, s[12:15], s46 offen offset:0 nt
    s_waitcnt vmcnt(4)
    buffer_load_dwordx4 v[20:23], v3, s[12:15], s46 offen offset:384 nt
    s_waitcnt vmcnt(4)
    buffer_load_dwordx4 v[24:27], v3, s[12:15], s46 offen offset:768 nt
    s_waitcnt vmcnt(4)
    buffer_load_dwordx4 v[28:31], v3, s[12:15], s46 offen offset:1152 nt
    s_waitcnt vmcnt(4)
    buffer_load_dwordx4 v[32:35], v4, s[12:15], s46 offen offset:0 nt
    s_waitcnt vmcnt(4)
    buffer_load_dwordx4 v[36:39], v4, s[12:15], s46 offen offset:768 nt
    s_waitcnt vmcnt(4)
    buffer_load_dwordx4 v[40:43], v3, s[12:15], s47 offen offset:0 nt
    s_waitcnt vmcnt(4)
    buffer_load_dwordx4 v[44:47], v3, s[12:15], s47 offen offset:384 nt
    s_waitcnt vmcnt(4)
    buffer_load_dwordx4 v[48:51], v3, s[12:15], s47 offen offset:768 nt
    s_waitcnt vmcnt(4)
    buffer_load_dwordx4 v[52:55], v3, s[12:15], s47 offen offset:1152 nt
    s_waitcnt vmcnt(4)
    buffer_load_dwordx4 v[56:59], v4, s[12:15], s47 offen offset:0 nt
    s_waitcnt vmcnt(4)
    buffer_load_dwordx4 v[60:63], v4, s[12:15], s47 offen offset:768 nt
    s_waitcnt vmcnt(4)
    buffer_load_dwordx4 v[64:67], v3, s[12:15], s48 offen offset:0 nt
    s_waitcnt vmcnt(4)
    buffer_load_dwordx4 v[68:71], v3, s[12:15], s48 offen offset:384 nt
    s_waitcnt vmcnt(4)
    buffer_load_dwordx4 v[72:75], v3, s[12:15], s48 offen offset:768 nt
    s_waitcnt vmcnt(4)
    buffer_load_dwordx4 v[76:79], v3, s[12:15], s48 offen offset:1152 nt
    s_waitcnt vmcnt(4)
    buffer_load_dwordx4 v[80:83], v4, s[12:15], s48 offen offset:0 nt
    s_waitcnt vmcnt(4)
    buffer_load_dwordx4 v[84:87], v4, s[12:15], s48 offen offset:768 nt
    s_waitcnt vmcnt(4)
    buffer_load_dwordx4 v[88:91], v3, s[12:15], s49 offen offset:0 nt
    s_waitcnt vmcnt(4)
    buffer_load_dwordx4 v[92:95], v3, s[12:15], s49 offen offset:384 nt
    s_waitcnt vmcnt(4)
    buffer_load_dwordx4 v[96:99], v3, s[12:15], s49 offen offset:768 nt
    s_waitcnt vmcnt(4)
    buffer_load_dwordx4 v[100:103], v3, s[12:15], s49 offen offset:1152 nt
    s_waitcnt vmcnt(4)
    buffer_load_dwordx4 v[104:107], v4, s[12:15], s49 offen offset:0 nt
    s_waitcnt vmcnt(4)
    buffer_load_dwordx4 v[108:111], v4, s[12:15], s49 offen offset:768 nt
    s_branch L_kdone
L_kold:
    s_waitcnt vmcnt(7)
    buffer_load_dwordx4 v[64:67], v3, s[12:15], s48 offen offset:0 nt
    s_waitcnt vmcnt(7)
    buffer_load_dwordx4 v[68:71], v3, s[12:15], s48 offen offset:384 nt
    s_waitcnt vmcnt(7)
    buffer_load_dwordx4 v[72:75], v3, s[12:15], s48 offen offset:768 nt
    s_waitcnt vmcnt(7)
    buffer_load_dwordx4 v[76:79], v3, s[12:15], s48 offen offset:1152 nt
    s_waitcnt vmcnt(7)
    buffer_load_dwordx4 v[80:83], v4, s[12:15], s48 offen offset:0 nt
    s_waitcnt vmcnt(7)
    buffer_load_dwordx4 v[84:87], v4, s[12:15], s48 offen offset:768 nt
    s_waitcnt vmcnt(7)
    buffer_load_dwordx4 v[88:91], v3, s[12:15], s49 offen offset:0 nt
    s_waitcnt vmcnt(7)
    buffer_load_dwordx4 v[92:95], v3, s[12:15], s49 offen offset:384 nt
    s_waitcnt vmcnt(7)
    buffer_load_dwordx4 v[96:99], v3, s[12:15], s49 offen offset:768 nt
    s_waitcnt vmcnt(7)
    buffer_load_dwordx4 v[100:103], v3, s[12:15], s49 offen offset:1152 nt
    s_waitcnt vmcnt(7)
    buffer_load_dwordx4 v[104:107], v4, s[12:15], s49 offen offset:0 nt
    s_waitcnt vmcnt(7)
    buffer_load_dwordx4 v[108:111], v4, s[12:15], s49 offen offset:768 nt
L_kdone:
    v_mov_b32 v172, 0
    s_mov_b32 s58, 0
L_qw:
    ds_read_b32 v171, v172 offset:8704
    s_waitcnt lgkmcnt(0)
    v_readfirstlane_b32 s52, v171
    s_nop 0
    s_cmp_eq_u32 s52, 1
    s_cbranch_scc1 L_qw_ok
    s_sleep 2
    s_add_u32 s58, s58, 1
    s_cmp_lt_u32 s58, 524288
    s_cbranch_scc1 L_qw
L_qw_ok:
    v_lshlrev_b32 v171, 4, v1
    v_and_b32 v172, 7, v1
    v_lshlrev_b32 v172, 4, v172
    ds_read_b128 v[128:131], v171 offset:8192
    ds_read_b128 v[132:135], v172 offset:8448
    s_waitcnt lgkmcnt(0)
    s_waitcnt vmcnt(18)
    v_mov_b32 v168, 0
    v_mov_b32 v169, 0
    v_mov_b32 v170, 0
    v_mov_b32 v171, 0
    v_mov_b32 v172, 0
    v_mov_b32 v173, 0
    v_dot2c_f32_bf16 v168, v16, v128
    v_dot2c_f32_bf16 v169, v20, v128
    v_dot2c_f32_bf16 v170, v24, v128
    v_dot2c_f32_bf16 v171, v28, v128
    v_dot2c_f32_bf16 v172, v32, v132
    v_dot2c_f32_bf16 v173, v36, v132
    v_dot2c_f32_bf16 v168, v17, v129
    v_dot2c_f32_bf16 v169, v21, v129
    v_dot2c_f32_bf16 v170, v25, v129
    v_dot2c_f32_bf16 v171, v29, v129
    v_dot2c_f32_bf16 v172, v33, v133
    v_dot2c_f32_bf16 v173, v37, v133
    v_dot2c_f32_bf16 v168, v18, v130
    v_dot2c_f32_bf16 v169, v22, v130
    v_dot2c_f32_bf16 v170, v26, v130
    v_dot2c_f32_bf16 v171, v30, v130
    v_dot2c_f32_bf16 v172, v34, v134
    v_dot2c_f32_bf16 v173, v38, v134
    v_dot2c_f32_bf16 v168, v19, v131
    v_dot2c_f32_bf16 v169, v23, v131
    v_dot2c_f32_bf16 v170, v27, v131
    v_dot2c_f32_bf16 v171, v31, v131
    v_dot2c_f32_bf16 v172, v35, v135
    v_dot2c_f32_bf16 v173, v39, v135
    s_nop 1
    v_fmac_f32 v168, v172, v9
    v_fmac_f32 v169, v172, v10
    v_fmac_f32 v170, v173, v9
    v_fmac_f32 v171, v173, v10
    v_add_f32_dpp v168, v168, v168 row_ror:8 row_mask:0xf bank_mask:0xf
    v_add_f32_dpp v169, v169, v169 row_ror:8 row_mask:0xf bank_mask:0xf
    v_add_f32_dpp v170, v170, v170 row_ror:8 row_mask:0xf bank_mask:0xf
    v_add_f32_dpp v171, v171, v171 row_ror:8 row_mask:0xf bank_mask:0xf
    v_add_f32_dpp v168, v168, v168 row_ror:4 row_mask:0xf bank_mask:0xf
    v_add_f32_dpp v169, v169, v169 row_ror:4 row_mask:0xf bank_mask:0xf
    v_add_f32_dpp v170, v170, v170 row_ror:4 row_mask:0xf bank_mask:0xf
    v_add_f32_dpp v171, v171, v171 row_ror:4 row_mask:0xf bank_mask:0xf
    v_add_f32_dpp v168, v168, v168 row_ror:2 row_mask:0xf bank_mask:0xf
    v_add_f32_dpp v169, v169, v169 row_ror:2 row_mask:0xf bank_mask:0xf
    v_add_f32_dpp v170, v170, v170 row_ror:2 row_mask:0xf bank_mask:0xf
    v_add_f32_dpp v171, v171, v171 row_ror:2 row_mask:0xf bank_mask:0xf
    v_add_f32_dpp v168, v168, v168 row_ror:1 row_mask:0xf bank_mask:0xf
    v_add_f32_dpp v169, v169, v169 row_ror:1 row_mask:0xf bank_mask:0xf
    v_add_f32_dpp v170, v170, v170 row_ror:1 row_mask:0xf bank_mask:0xf
    v_add_f32_dpp v171, v171, v171 row_ror:1 row_mask:0xf bank_mask:0xf
    v_cvt_pk_bf16_f32 v174, v168, v169
    v_lshlrev_b32 v168, 16, v174
    v_and_b32 v169, 0xffff0000, v174
    v_cvt_pk_bf16_f32 v175, v170, v171
    v_lshlrev_b32 v170, 16, v175
    v_and_b32 v171, 0xffff0000, v175
    v_mul_f32 v168, 0x3d93cd3a, v168
    v_mul_f32 v169, 0x3d93cd3a, v169
    v_mul_f32 v170, 0x3d93cd3a, v170
    v_mul_f32 v171, 0x3d93cd3a, v171
    v_cvt_pk_bf16_f32 v174, v168, v169
    v_cvt_pk_bf16_f32 v175, v170, v171
    v_lshlrev_b32 v112, 16, v174
    v_and_b32 v113, 0xffff0000, v174
    v_lshlrev_b32 v114, 16, v175
    v_and_b32 v115, 0xffff0000, v175
    s_waitcnt vmcnt(12)
    v_mov_b32 v168, 0
    v_mov_b32 v169, 0
    v_mov_b32 v170, 0
    v_mov_b32 v171, 0
    v_mov_b32 v172, 0
    v_mov_b32 v173, 0
    v_dot2c_f32_bf16 v168, v40, v128
    v_dot2c_f32_bf16 v169, v44, v128
    v_dot2c_f32_bf16 v170, v48, v128
    v_dot2c_f32_bf16 v171, v52, v128
    v_dot2c_f32_bf16 v172, v56, v132
    v_dot2c_f32_bf16 v173, v60, v132
    v_dot2c_f32_bf16 v168, v41, v129
    v_dot2c_f32_bf16 v169, v45, v129
    v_dot2c_f32_bf16 v170, v49, v129
    v_dot2c_f32_bf16 v171, v53, v129
    v_dot2c_f32_bf16 v172, v57, v133
    v_dot2c_f32_bf16 v173, v61, v133
    v_dot2c_f32_bf16 v168, v42, v130
    v_dot2c_f32_bf16 v169, v46, v130
    v_dot2c_f32_bf16 v170, v50, v130
    v_dot2c_f32_bf16 v171, v54, v130
    v_dot2c_f32_bf16 v172, v58, v134
    v_dot2c_f32_bf16 v173, v62, v134
    v_dot2c_f32_bf16 v168, v43, v131
    v_dot2c_f32_bf16 v169, v47, v131
    v_dot2c_f32_bf16 v170, v51, v131
    v_dot2c_f32_bf16 v171, v55, v131
    v_dot2c_f32_bf16 v172, v59, v135
    v_dot2c_f32_bf16 v173, v63, v135
    s_nop 1
    v_fmac_f32 v168, v172, v9
    v_fmac_f32 v169, v172, v10
    v_fmac_f32 v170, v173, v9
    v_fmac_f32 v171, v173, v10
    v_add_f32_dpp v168, v168, v168 row_ror:8 row_mask:0xf bank_mask:0xf
    v_add_f32_dpp v169, v169, v169 row_ror:8 row_mask:0xf bank_mask:0xf
    v_add_f32_dpp v170, v170, v170 row_ror:8 row_mask:0xf bank_mask:0xf
    v_add_f32_dpp v171, v171, v171 row_ror:8 row_mask:0xf bank_mask:0xf
    v_add_f32_dpp v168, v168, v168 row_ror:4 row_mask:0xf bank_mask:0xf
    v_add_f32_dpp v169, v169, v169 row_ror:4 row_mask:0xf bank_mask:0xf
    v_add_f32_dpp v170, v170, v170 row_ror:4 row_mask:0xf bank_mask:0xf
    v_add_f32_dpp v171, v171, v171 row_ror:4 row_mask:0xf bank_mask:0xf
    v_add_f32_dpp v168, v168, v168 row_ror:2 row_mask:0xf bank_mask:0xf
    v_add_f32_dpp v169, v169, v169 row_ror:2 row_mask:0xf bank_mask:0xf
    v_add_f32_dpp v170, v170, v170 row_ror:2 row_mask:0xf bank_mask:0xf
    v_add_f32_dpp v171, v171, v171 row_ror:2 row_mask:0xf bank_mask:0xf
    v_add_f32_dpp v168, v168, v168 row_ror:1 row_mask:0xf bank_mask:0xf
    v_add_f32_dpp v169, v169, v169 row_ror:1 row_mask:0xf bank_mask:0xf
    v_add_f32_dpp v170, v170, v170 row_ror:1 row_mask:0xf bank_mask:0xf
    v_add_f32_dpp v171, v171, v171 row_ror:1 row_mask:0xf bank_mask:0xf
    v_cvt_pk_bf16_f32 v174, v168, v169
    v_lshlrev_b32 v168, 16, v174
    v_and_b32 v169, 0xffff0000, v174
    v_cvt_pk_bf16_f32 v175, v170, v171
    v_lshlrev_b32 v170, 16, v175
    v_and_b32 v171, 0xffff0000, v175
    v_mul_f32 v168, 0x3d93cd3a, v168
    v_mul_f32 v169, 0x3d93cd3a, v169
    v_mul_f32 v170, 0x3d93cd3a, v170
    v_mul_f32 v171, 0x3d93cd3a, v171
    v_cvt_pk_bf16_f32 v174, v168, v169
    v_cvt_pk_bf16_f32 v175, v170, v171
    v_lshlrev_b32 v116, 16, v174
    v_and_b32 v117, 0xffff0000, v174
    v_lshlrev_b32 v118, 16, v175
    v_and_b32 v119, 0xffff0000, v175
    s_waitcnt vmcnt(6)
    v_mov_b32 v168, 0
    v_mov_b32 v169, 0
    v_mov_b32 v170, 0
    v_mov_b32 v171, 0
    v_mov_b32 v172, 0
    v_mov_b32 v173, 0
    v_dot2c_f32_bf16 v168, v64, v128
    v_dot2c_f32_bf16 v169, v68, v128
    v_dot2c_f32_bf16 v170, v72, v128
    v_dot2c_f32_bf16 v171, v76, v128
    v_dot2c_f32_bf16 v172, v80, v132
    v_dot2c_f32_bf16 v173, v84, v132
    v_dot2c_f32_bf16 v168, v65, v129
    v_dot2c_f32_bf16 v169, v69, v129
    v_dot2c_f32_bf16 v170, v73, v129
    v_dot2c_f32_bf16 v171, v77, v129
    v_dot2c_f32_bf16 v172, v81, v133
    v_dot2c_f32_bf16 v173, v85, v133
    v_dot2c_f32_bf16 v168, v66, v130
    v_dot2c_f32_bf16 v169, v70, v130
    v_dot2c_f32_bf16 v170, v74, v130
    v_dot2c_f32_bf16 v171, v78, v130
    v_dot2c_f32_bf16 v172, v82, v134
    v_dot2c_f32_bf16 v173, v86, v134
    v_dot2c_f32_bf16 v168, v67, v131
    v_dot2c_f32_bf16 v169, v71, v131
    v_dot2c_f32_bf16 v170, v75, v131
    v_dot2c_f32_bf16 v171, v79, v131
    v_dot2c_f32_bf16 v172, v83, v135
    v_dot2c_f32_bf16 v173, v87, v135
    s_nop 1
    v_fmac_f32 v168, v172, v9
    v_fmac_f32 v169, v172, v10
    v_fmac_f32 v170, v173, v9
    v_fmac_f32 v171, v173, v10
    v_add_f32_dpp v168, v168, v168 row_ror:8 row_mask:0xf bank_mask:0xf
    v_add_f32_dpp v169, v169, v169 row_ror:8 row_mask:0xf bank_mask:0xf
    v_add_f32_dpp v170, v170, v170 row_ror:8 row_mask:0xf bank_mask:0xf
    v_add_f32_dpp v171, v171, v171 row_ror:8 row_mask:0xf bank_mask:0xf
    v_add_f32_dpp v168, v168, v168 row_ror:4 row_mask:0xf bank_mask:0xf
    v_add_f32_dpp v169, v169, v169 row_ror:4 row_mask:0xf bank_mask:0xf
    v_add_f32_dpp v170, v170, v170 row_ror:4 row_mask:0xf bank_mask:0xf
    v_add_f32_dpp v171, v171, v171 row_ror:4 row_mask:0xf bank_mask:0xf
    v_add_f32_dpp v168, v168, v168 row_ror:2 row_mask:0xf bank_mask:0xf
    v_add_f32_dpp v169, v169, v169 row_ror:2 row_mask:0xf bank_mask:0xf
    v_add_f32_dpp v170, v170, v170 row_ror:2 row_mask:0xf bank_mask:0xf
    v_add_f32_dpp v171, v171, v171 row_ror:2 row_mask:0xf bank_mask:0xf
    v_add_f32_dpp v168, v168, v168 row_ror:1 row_mask:0xf bank_mask:0xf
    v_add_f32_dpp v169, v169, v169 row_ror:1 row_mask:0xf bank_mask:0xf
    v_add_f32_dpp v170, v170, v170 row_ror:1 row_mask:0xf bank_mask:0xf
    v_add_f32_dpp v171, v171, v171 row_ror:1 row_mask:0xf bank_mask:0xf
    v_cvt_pk_bf16_f32 v174, v168, v169
    v_lshlrev_b32 v168, 16, v174
    v_and_b32 v169, 0xffff0000, v174
    v_cvt_pk_bf16_f32 v175, v170, v171
    v_lshlrev_b32 v170, 16, v175
    v_and_b32 v171, 0xffff0000, v175
    v_mul_f32 v168, 0x3d93cd3a, v168
    v_mul_f32 v169, 0x3d93cd3a, v169
    v_mul_f32 v170, 0x3d93cd3a, v170
    v_mul_f32 v171, 0x3d93cd3a, v171
    v_cvt_pk_bf16_f32 v174, v168, v169
    v_cvt_pk_bf16_f32 v175, v170, v171
    v_lshlrev_b32 v120, 16, v174
    v_and_b32 v121, 0xffff0000, v174
    v_lshlrev_b32 v122, 16, v175
    v_and_b32 v123, 0xffff0000, v175
    s_waitcnt vmcnt(0)
    v_mov_b32 v168, 0
    v_mov_b32 v169, 0
    v_mov_b32 v170, 0
    v_mov_b32 v171, 0
    v_mov_b32 v172, 0
    v_mov_b32 v173, 0
    v_dot2c_f32_bf16 v168, v88, v128
    v_dot2c_f32_bf16 v169, v92, v128
    v_dot2c_f32_bf16 v170, v96, v128
    v_dot2c_f32_bf16 v171, v100, v128
    v_dot2c_f32_bf16 v172, v104, v132
    v_dot2c_f32_bf16 v173, v108, v132
    v_dot2c_f32_bf16 v168, v89, v129
    v_dot2c_f32_bf16 v169, v93, v129
    v_dot2c_f32_bf16 v170, v97, v129
    v_dot2c_f32_bf16 v171, v101, v129
    v_dot2c_f32_bf16 v172, v105, v133
    v_dot2c_f32_bf16 v173, v109, v133
    v_dot2c_f32_bf16 v168, v90, v130
    v_dot2c_f32_bf16 v169, v94, v130
    v_dot2c_f32_bf16 v170, v98, v130
    v_dot2c_f32_bf16 v171, v102, v130
    v_dot2c_f32_bf16 v172, v106, v134
    v_dot2c_f32_bf16 v173, v110, v134
    v_dot2c_f32_bf16 v168, v91, v131
    v_dot2c_f32_bf16 v169, v95, v131
    v_dot2c_f32_bf16 v170, v99, v131
    v_dot2c_f32_bf16 v171, v103, v131
    v_dot2c_f32_bf16 v172, v107, v135
    v_dot2c_f32_bf16 v173, v111, v135
    s_nop 1
    v_fmac_f32 v168, v172, v9
    v_fmac_f32 v169, v172, v10
    v_fmac_f32 v170, v173, v9
    v_fmac_f32 v171, v173, v10
    v_add_f32_dpp v168, v168, v168 row_ror:8 row_mask:0xf bank_mask:0xf
    v_add_f32_dpp v169, v169, v169 row_ror:8 row_mask:0xf bank_mask:0xf
    v_add_f32_dpp v170, v170, v170 row_ror:8 row_mask:0xf bank_mask:0xf
    v_add_f32_dpp v171, v171, v171 row_ror:8 row_mask:0xf bank_mask:0xf
    v_add_f32_dpp v168, v168, v168 row_ror:4 row_mask:0xf bank_mask:0xf
    v_add_f32_dpp v169, v169, v169 row_ror:4 row_mask:0xf bank_mask:0xf
    v_add_f32_dpp v170, v170, v170 row_ror:4 row_mask:0xf bank_mask:0xf
    v_add_f32_dpp v171, v171, v171 row_ror:4 row_mask:0xf bank_mask:0xf
    v_add_f32_dpp v168, v168, v168 row_ror:2 row_mask:0xf bank_mask:0xf
    v_add_f32_dpp v169, v169, v169 row_ror:2 row_mask:0xf bank_mask:0xf
    v_add_f32_dpp v170, v170, v170 row_ror:2 row_mask:0xf bank_mask:0xf
    v_add_f32_dpp v171, v171, v171 row_ror:2 row_mask:0xf bank_mask:0xf
    v_add_f32_dpp v168, v168, v168 row_ror:1 row_mask:0xf bank_mask:0xf
    v_add_f32_dpp v169, v169, v169 row_ror:1 row_mask:0xf bank_mask:0xf
    v_add_f32_dpp v170, v170, v170 row_ror:1 row_mask:0xf bank_mask:0xf
    v_add_f32_dpp v171, v171, v171 row_ror:1 row_mask:0xf bank_mask:0xf
    v_cvt_pk_bf16_f32 v174, v168, v169
    v_lshlrev_b32 v168, 16, v174
    v_and_b32 v169, 0xffff0000, v174
    v_cvt_pk_bf16_f32 v175, v170, v171
    v_lshlrev_b32 v170, 16, v175
    v_and_b32 v171, 0xffff0000, v175
    v_mul_f32 v168, 0x3d93cd3a, v168
    v_mul_f32 v169, 0x3d93cd3a, v169
    v_mul_f32 v170, 0x3d93cd3a, v170
    v_mul_f32 v171, 0x3d93cd3a, v171
    v_cvt_pk_bf16_f32 v174, v168, v169
    v_cvt_pk_bf16_f32 v175, v170, v171
    v_lshlrev_b32 v124, 16, v174
    v_and_b32 v125, 0xffff0000, v174
    v_lshlrev_b32 v126, 16, v175
    v_and_b32 v127, 0xffff0000, v175
    s_cmp_eq_u32 s4, 6
    s_cbranch_scc0 L_nomode
    s_getreg_b32 s93, hwreg(HW_REG_XCC_ID, 0, 4)
    s_mov_b32 s58, 0
L_xdp:
    v_bitop3_b32 v172, v184, v185, s9 bitop3:0x7e
    v_bitop3_b32 v173, v186, v187, s9 bitop3:0x7e
    v_bitop3_b32 v172, v172, v173, v15 bitop3:0x54
    v_cmp_ne_u32 vcc, 0, v172
    s_cbranch_vccz L_xdp_ok
    buffer_load_dwordx4 v[184:187], v231, s[20:23], s94 offen sc1
    s_waitcnt vmcnt(0)
    s_add_u32 s58, s58, 1
    s_cmp_lt_u32 s58, 32768
    s_cbranch_scc1 L_xdp
L_xdp_ok:
    v_lshrrev_b32 v184, 16, v184
    s_add_u32 s52, s93, 1
    v_cmp_ne_u32 vcc, s52, v184
    s_nop 0
    s_cmp_eq_u64 vcc, 0
    s_cselect_b32 s53, 1, 0
    v_mov_b32 v172, 0
    v_mov_b32 v173, s53
    ds_write_b32 v172, v173 offset:8708
L_nomode:
    v_max3_f32 v229, v112, v113, v114
    v_max3_f32 v229, v229, v115, v116
    v_max3_f32 v229, v229, v117, v118
    v_max3_f32 v229, v229, v119, v120
    v_max3_f32 v229, v229, v121, v122
    v_max3_f32 v229, v229, v123, v124
    v_max3_f32 v229, v229, v125, v126
    v_max_f32 v229, v229, v127
    v_mov_b32 v171, v229
    s_nop 1
    v_permlane16_swap_b32 v229, v171
    v_max_f32 v229, v229, v171
    v_mov_b32 v171, v229
    s_nop 1
    v_permlane32_swap_b32 v229, v171
    v_max_f32 v229, v229, v171
    s_lshl_b32 s52, s4, 2
    v_mov_b32 v171, s52
    ds_write_b32 v171, v229 offset:8768
    s_mov_b32 s52, 0x3fb8aa3b
    v_sub_f32 v112, v112, v229
    v_sub_f32 v113, v113, v229
    v_sub_f32 v114, v114, v229
    v_sub_f32 v115, v115, v229
    v_sub_f32 v116, v116, v229
    v_sub_f32 v117, v117, v229
    v_sub_f32 v118, v118, v229
    v_sub_f32 v119, v119, v229
    v_sub_f32 v120, v120, v229
    v_sub_f32 v121, v121, v229
    v_sub_f32 v122, v122, v229
    v_sub_f32 v123, v123, v229
    v_sub_f32 v124, v124, v229
    v_sub_f32 v125, v125, v229
    v_sub_f32 v126, v126, v229
    v_sub_f32 v127, v127, v229
    v_mul_f32 v112, s52, v112
    v_mul_f32 v113, s52, v113
    v_mul_f32 v114, s52, v114
    v_mul_f32 v115, s52, v115
    v_mul_f32 v116, s52, v116
    v_mul_f32 v117, s52, v117
    v_mul_f32 v118, s52, v118
    v_mul_f32 v119, s52, v119
    v_mul_f32 v120, s52, v120
    v_mul_f32 v121, s52, v121
    v_mul_f32 v122, s52, v122
    v_mul_f32 v123, s52, v123
    v_mul_f32 v124, s52, v124
    v_mul_f32 v125, s52, v125
    v_mul_f32 v126, s52, v126
    v_mul_f32 v127, s52, v127
    v_exp_f32 v112, v112
    v_exp_f32 v113, v113
    v_exp_f32 v114, v114
    v_exp_f32 v115, v115
    v_exp_f32 v116, v116
    v_exp_f32 v117, v117
    v_exp_f32 v118, v118
    v_exp_f32 v119, v119
    v_exp_f32 v120, v120
    v_exp_f32 v121, v121
    v_exp_f32 v122, v122
    v_exp_f32 v123, v123
    v_exp_f32 v124, v124
    v_exp_f32 v125, v125
    v_exp_f32 v126, v126
    v_exp_f32 v127, v127
    v_add_f32 v228, v112, v113
    v_add_f32 v228, v228, v114
    v_add_f32 v228, v228, v115
    v_add_f32 v228, v228, v116
    v_add_f32 v228, v228, v117
    v_add_f32 v228, v228, v118
    v_add_f32 v228, v228, v119
    v_add_f32 v228, v228, v120
    v_add_f32 v228, v228, v121
    v_add_f32 v228, v228, v122
    v_add_f32 v228, v228, v123
    v_add_f32 v228, v228, v124
    v_add_f32 v228, v228, v125
    v_add_f32 v228, v228, v126
    v_add_f32 v228, v228, v127
    v_mov_b32 v171, v228
    s_nop 1
    v_permlane16_swap_b32 v228, v171
    v_add_f32 v228, v228, v171
    v_mov_b32 v171, v228
    s_nop 1
    v_permlane32_swap_b32 v228, v171
    v_add_f32 v228, v228, v171
    v_cvt_pk_bf16_f32 v112, v112, v112
    v_cvt_pk_bf16_f32 v113, v113, v113
    v_cvt_pk_bf16_f32 v114, v114, v114
    v_cvt_pk_bf16_f32 v115, v115, v115
    v_cvt_pk_bf16_f32 v116, v116, v116
    v_cvt_pk_bf16_f32 v117, v117, v117
    v_cvt_pk_bf16_f32 v118, v118, v118
    v_cvt_pk_bf16_f32 v119, v119, v119
    v_cvt_pk_bf16_f32 v120, v120, v120
    v_cvt_pk_bf16_f32 v121, v121, v121
    v_cvt_pk_bf16_f32 v122, v122, v122
    v_cvt_pk_bf16_f32 v123, v123, v123
    v_cvt_pk_bf16_f32 v124, v124, v124
    v_cvt_pk_bf16_f32 v125, v125, v125
    v_cvt_pk_bf16_f32 v126, v126, v126
    v_cvt_pk_bf16_f32 v127, v127, v127
    s_cmp_lt_u32 s4, 4
    s_cbranch_scc1 L_nolate
    s_mov_b32 s54, 0xbdd2d3e8
    s_mov_b32 s55, 0xbdd2d3e8
    s_mov_b32 s56, 1.0
    s_mov_b32 s57, 1.0
    v_mov_b32 v12, 0xc0135761
    v_mov_b32 v13, 0xc0135761
    s_sub_u32 s59, s4, 4
    s_mul_i32 s59, s59, 1
    s_add_u32 s59, s59, 6
    s_add_u32 s60, s59, 1
L_tl:
    s_lshl_b32 s52, s2, 4
    s_add_u32 s52, s52, s59
    s_lshr_b32 s53, s52, 11
    s_lshl_b32 s53, s53, 31
    s_and_b32 s52, s52, 2047
    s_add_u32 s52, s52, 14592
    s_lshl_b32 s52, s52, 16
    s_or_b32 s50, s52, s53
    s_mov_b32 s51, s50
    s_call_b64 s[62:63], L_entry
    s_and_b32 s52, s92, 0xffff
    v_or_b32 v168, s52, v168
    v_mov_b32 v169, s92
    s_lshl_b32 s52, s2, 4
    s_add_u32 s52, s52, s59
    s_lshl_b32 s52, s52, 3
    s_add_u32 s52, s52, 1335296
    v_mov_b32 v170, 0
    s_mov_b64 exec, 1
    buffer_store_dwordx2 v[168:169], v170, s[20:23], s52 offen sc1
    s_mov_b64 exec, -1
    s_add_u32 s59, s59, 1
    s_cmp_lt_u32 s59, s60
    s_cbranch_scc1 L_tl
L_nolate:
    s_setprio 1
    v_mov_b32 v136, 0
    v_mov_b32 v137, 0
    v_mov_b32 v138, 0
    v_mov_b32 v139, 0
    v_mov_b32 v140, 0
    v_mov_b32 v141, 0
    v_mov_b32 v142, 0
    v_mov_b32 v143, 0
    s_mov_b32 s54, 0xff00ff00
    s_mov_b32 s55, 0xff00ff00
    s_cmp_lt_u32 s4, 4
    s_cbranch_scc0 L_vy
    s_waitcnt vmcnt(3)
    buffer_load_dwordx4 v[16:19], v3, s[16:19], s46 offen offset:0 nt
    s_waitcnt vmcnt(3)
    buffer_load_dwordx4 v[20:23], v3, s[16:19], s46 offen offset:384 nt
    s_waitcnt vmcnt(3)
    buffer_load_dwordx4 v[24:27], v3, s[16:19], s46 offen offset:768 nt
    s_waitcnt vmcnt(3)
    buffer_load_dwordx4 v[28:31], v3, s[16:19], s46 offen offset:1152 nt
    s_waitcnt vmcnt(3)
    buffer_load_dwordx4 v[32:35], v4, s[16:19], s46 offen offset:0 nt
    s_waitcnt vmcnt(3)
    buffer_load_dwordx4 v[36:39], v4, s[16:19], s46 offen offset:768 nt
    s_waitcnt vmcnt(3)
    buffer_load_dwordx4 v[40:43], v3, s[16:19], s47 offen offset:0 nt
    s_waitcnt vmcnt(3)
    buffer_load_dwordx4 v[44:47], v3, s[16:19], s47 offen offset:384 nt
    s_waitcnt vmcnt(3)
    buffer_load_dwordx4 v[48:51], v3, s[16:19], s47 offen offset:768 nt
    s_waitcnt vmcnt(3)
    buffer_load_dwordx4 v[52:55], v3, s[16:19], s47 offen offset:1152 nt
    s_waitcnt vmcnt(3)
    buffer_load_dwordx4 v[56:59], v4, s[16:19], s47 offen offset:0 nt
    s_waitcnt vmcnt(3)
    buffer_load_dwordx4 v[60:63], v4, s[16:19], s47 offen offset:768 nt
    s_waitcnt vmcnt(5)
    buffer_load_dwordx4 v[64:67], v3, s[16:19], s48 offen offset:0 nt
    s_waitcnt vmcnt(5)
    buffer_load_dwordx4 v[68:71], v3, s[16:19], s48 offen offset:384 nt
    s_waitcnt vmcnt(5)
    buffer_load_dwordx4 v[72:75], v3, s[16:19], s48 offen offset:768 nt
    s_waitcnt vmcnt(5)
    buffer_load_dwordx4 v[76:79], v3, s[16:19], s48 offen offset:1152 nt
    s_waitcnt vmcnt(5)
    buffer_load_dwordx4 v[80:83], v4, s[16:19], s48 offen offset:0 nt
    s_waitcnt vmcnt(5)
    buffer_load_dwordx4 v[84:87], v4, s[16:19], s48 offen offset:768 nt
    s_waitcnt vmcnt(5)
    buffer_load_dwordx4 v[88:91], v3, s[16:19], s49 offen offset:0 nt
    s_waitcnt vmcnt(5)
    buffer_load_dwordx4 v[92:95], v3, s[16:19], s49 offen offset:384 nt
    s_waitcnt vmcnt(5)
    buffer_load_dwordx4 v[96:99], v3, s[16:19], s49 offen offset:768 nt
    s_waitcnt vmcnt(5)
    buffer_load_dwordx4 v[100:103], v3, s[16:19], s49 offen offset:1152 nt
    s_waitcnt vmcnt(5)
    buffer_load_dwordx4 v[104:107], v4, s[16:19], s49 offen offset:0 nt
    s_waitcnt vmcnt(5)
    buffer_load_dwordx4 v[108:111], v4, s[16:19], s49 offen offset:768 nt
    s_branch L_vd
L_vy:
    s_waitcnt vmcnt(7)
    buffer_load_dwordx4 v[16:19], v3, s[16:19], s46 offen offset:0 nt
    s_waitcnt vmcnt(7)
    buffer_load_dwordx4 v[20:23], v3, s[16:19], s46 offen offset:384 nt
    s_waitcnt vmcnt(7)
    buffer_load_dwordx4 v[24:27], v3, s[16:19], s46 offen offset:768 nt
    s_waitcnt vmcnt(7)
    buffer_load_dwordx4 v[28:31], v3, s[16:19], s46 offen offset:1152 nt
    s_waitcnt vmcnt(7)
    buffer_load_dwordx4 v[32:35], v4, s[16:19], s46 offen offset:0 nt
    s_waitcnt vmcnt(7)
    buffer_load_dwordx4 v[36:39], v4, s[16:19], s46 offen offset:768 nt
    s_waitcnt vmcnt(7)
    buffer_load_dwordx4 v[40:43], v3, s[16:19], s47 offen offset:0 nt
    s_waitcnt vmcnt(7)
    buffer_load_dwordx4 v[44:47], v3, s[16:19], s47 offen offset:384 nt
    s_waitcnt vmcnt(7)
    buffer_load_dwordx4 v[48:51], v3, s[16:19], s47 offen offset:768 nt
    s_waitcnt vmcnt(7)
    buffer_load_dwordx4 v[52:55], v3, s[16:19], s47 offen offset:1152 nt
    s_waitcnt vmcnt(7)
    buffer_load_dwordx4 v[56:59], v4, s[16:19], s47 offen offset:0 nt
    s_waitcnt vmcnt(7)
    buffer_load_dwordx4 v[60:63], v4, s[16:19], s47 offen offset:768 nt
    s_waitcnt vmcnt(11)
    buffer_load_dwordx4 v[64:67], v3, s[16:19], s48 offen offset:0 nt
    s_waitcnt vmcnt(11)
    buffer_load_dwordx4 v[68:71], v3, s[16:19], s48 offen offset:384 nt
    s_waitcnt vmcnt(11)
    buffer_load_dwordx4 v[72:75], v3, s[16:19], s48 offen offset:768 nt
    s_waitcnt vmcnt(11)
    buffer_load_dwordx4 v[76:79], v3, s[16:19], s48 offen offset:1152 nt
    s_waitcnt vmcnt(11)
    buffer_load_dwordx4 v[80:83], v4, s[16:19], s48 offen offset:0 nt
    s_waitcnt vmcnt(11)
    buffer_load_dwordx4 v[84:87], v4, s[16:19], s48 offen offset:768 nt
    s_waitcnt vmcnt(11)
    buffer_load_dwordx4 v[88:91], v3, s[16:19], s49 offen offset:0 nt
    s_waitcnt vmcnt(11)
    buffer_load_dwordx4 v[92:95], v3, s[16:19], s49 offen offset:384 nt
    s_waitcnt vmcnt(11)
    buffer_load_dwordx4 v[96:99], v3, s[16:19], s49 offen offset:768 nt
    s_waitcnt vmcnt(11)
    buffer_load_dwordx4 v[100:103], v3, s[16:19], s49 offen offset:1152 nt
    s_waitcnt vmcnt(11)
    buffer_load_dwordx4 v[104:107], v4, s[16:19], s49 offen offset:0 nt
    s_waitcnt vmcnt(11)
    buffer_load_dwordx4 v[108:111], v4, s[16:19], s49 offen offset:768 nt
L_vd:
    s_cmp_lt_u32 s4, 4
    s_cbranch_scc1 L_nosig
    s_cmp_eq_u32 s4, 4
    s_cbranch_scc0 L_nowo4
    s_mul_i32 s52, s5, 192
    s_mul_i32 s53, s6, 24
    s_add_u32 s52, s52, s53
    s_mul_i32 s52, s52, 1280
    s_lshl_b32 s53, s4, 8
    s_add_u32 s52, s52, s53
    v_mul_u32_u24 v171, 1280, v2
    v_lshl_add_u32 v171, v1, 4, v171
    buffer_load_dwordx4 v[204:207], v171, s[28:31], s52 offen nt
    s_add_u32 s52, s52, 5120
    buffer_load_dwordx4 v[208:211], v171, s[28:31], s52 offen nt
    s_add_u32 s52, s52, 5120
    buffer_load_dwordx4 v[212:215], v171, s[28:31], s52 offen nt
    s_add_u32 s52, s52, 5120
    buffer_load_dwordx4 v[216:219], v171, s[28:31], s52 offen nt
    s_add_u32 s52, s52, 5120
    buffer_load_dwordx4 v[220:223], v171, s[28:31], s52 offen nt
    s_add_u32 s52, s52, 5120
    buffer_load_dwordx4 v[224:227], v171, s[28:31], s52 offen nt
L_nowo4:
    s_mov_b64 exec, 1
    v_mov_b32 v172, 0
    v_mov_b32 v173, 1
    ds_add_u32 v172, v173 offset:8716
    s_mov_b64 exec, -1
L_nosig:
    v_and_b32 v171, 7, v0
    v_lshlrev_b32 v171, 2, v171
    v_mov_b32 v172, 0
    s_mov_b32 s58, 0
L_mw:
    ds_read_b32 v175, v171 offset:8768
    ds_read_b32 v173, v172 offset:8708
    s_waitcnt lgkmcnt(0)
    v_cmp_eq_u32 vcc, -1, v175
    s_cbranch_vccz L_mw_ok
    s_sleep 1
    s_add_u32 s58, s58, 1
    s_cmp_lt_u32 s58, 524288
    s_cbranch_scc1 L_mw
L_mw_ok:
    v_readfirstlane_b32 s11, v173
    v_max_f32_dpp v175, v175, v175 row_ror:4 row_mask:0xf bank_mask:0xf
    s_nop 1
    v_max_f32_dpp v175, v175, v175 row_ror:2 row_mask:0xf bank_mask:0xf
    s_nop 1
    v_max_f32_dpp v175, v175, v175 row_ror:1 row_mask:0xf bank_mask:0xf
    v_sub_f32 v174, v229, v175
    v_mul_f32 v174, 0x3fb8aa3b, v174
    v_exp_f32 v174, v174
    v_and_b32 v171, 7, v1
    v_lshl_add_u32 v171, v2, 5, v171
    v_lshlrev_b32 v176, 5, v171
    s_lshl_b32 s52, s4, 2
    v_add_u32 v176, s52, v176
    v_mov_b32 v177, s52
    v_mul_f32 v228, v228, v174
    v_lshrrev_b32 v184, 3, v0
    v_mul_u32_u24 v184, 24, v184
    v_and_b32 v185, 1, v0
    v_mul_u32_u24 v185, 12, v185
    v_bfe_u32 v186, v0, 1, 2
    v_add3_u32 v184, v184, v185, v186
    v_lshlrev_b32 v184, 5, v184
    v_mov_b32 v185, 0
    v_lshlrev_b32 v186, 4, v0
    s_lshl_b32 s98, s5, 3
    s_add_u32 s98, s98, s6
    s_mul_i32 s98, s98, 1024
    s_add_u32 s98, s98, 262144
    v_bfe_u32 v232, v0, 1, 3
    v_mul_u32_u24 v232, 1024, v232
    v_and_b32 v233, 1, v0
    v_lshl_add_u32 v233, v2, 1, v233
    v_lshl_add_u32 v232, v233, 4, v232
    s_mul_i32 s94, s5, 8192
    s_lshl_b32 s95, s6, 7
    s_add_u32 s94, s94, s95
    s_add_u32 s94, s94, 262144
    v_lshl_add_u32 v233, v2, 3, v1
    v_lshlrev_b32 v233, 4, v233
    s_lshl_b32 s96, s8, 5
    s_add_u32 s95, s96, s7
    s_mul_i32 s95, s95, 2560
    s_lshl_b32 s97, s4, 9
    s_add_u32 s95, s95, s97
    s_add_u32 s95, s95, 589824
    v_and_b32 v234, 31, v0
    v_mul_u32_u24 v234, 2560, v234
    s_mul_i32 s96, s96, 2560
    s_mul_i32 s97, s7, 5
    s_add_u32 s97, s97, s4
    s_lshl_b32 s97, s97, 4
    s_add_u32 s96, s96, s97
    s_add_u32 s96, s96, 589824
    s_mul_i32 s99, s8, 2560
    s_add_u32 s97, s97, s99
    s_add_u32 s97, s97, 1310720
    v_mov_b32 v235, 0
    v_and_b32 v144, v112, v5
    v_and_b32 v145, v112, v6
    v_and_b32 v146, v112, v7
    v_and_b32 v147, v112, v8
    v_and_b32 v148, v113, v5
    v_and_b32 v149, v113, v6
    v_and_b32 v150, v113, v7
    v_and_b32 v151, v113, v8
    v_and_b32 v152, v114, v5
    v_and_b32 v153, v114, v6
    v_and_b32 v154, v114, v7
    v_and_b32 v155, v114, v8
    v_and_b32 v156, v115, v5
    v_and_b32 v157, v115, v6
    v_and_b32 v158, v115, v7
    v_and_b32 v159, v115, v8
    v_cndmask_b32 v171, v112, v113, s[54:55]
    v_and_b32 v160, v171, v5
    v_and_b32 v161, v171, v6
    v_and_b32 v162, v171, v7
    v_and_b32 v163, v171, v8
    v_cndmask_b32 v171, v114, v115, s[54:55]
    v_and_b32 v164, v171, v5
    v_and_b32 v165, v171, v6
    v_and_b32 v166, v171, v7
    v_and_b32 v167, v171, v8
    s_cmp_eq_u32 s4, 4
    s_cbranch_scc1 L_pvw4_0
    s_waitcnt vmcnt(18)
    s_branch L_pvwd_0
L_pvw4_0:
    s_waitcnt vmcnt(24)
L_pvwd_0:
    v_mfma_f32_16x16x32_bf16 v[136:139], v[16:19], v[144:147], v[136:139]
    v_mfma_f32_16x16x32_bf16 v[140:143], v[32:35], v[160:163], v[140:143]
    v_mfma_f32_16x16x32_bf16 v[136:139], v[20:23], v[148:151], v[136:139]
    v_mfma_f32_16x16x32_bf16 v[140:143], v[36:39], v[164:167], v[140:143]
    v_mfma_f32_16x16x32_bf16 v[136:139], v[24:27], v[152:155], v[136:139]
    v_mfma_f32_16x16x32_bf16 v[136:139], v[28:31], v[156:159], v[136:139]
    v_and_b32 v144, v116, v5
    v_and_b32 v145, v116, v6
    v_and_b32 v146, v116, v7
    v_and_b32 v147, v116, v8
    v_and_b32 v148, v117, v5
    v_and_b32 v149, v117, v6
    v_and_b32 v150, v117, v7
    v_and_b32 v151, v117, v8
    v_and_b32 v152, v118, v5
    v_and_b32 v153, v118, v6
    v_and_b32 v154, v118, v7
    v_and_b32 v155, v118, v8
    v_and_b32 v156, v119, v5
    v_and_b32 v157, v119, v6
    v_and_b32 v158, v119, v7
    v_and_b32 v159, v119, v8
    v_cndmask_b32 v171, v116, v117, s[54:55]
    v_and_b32 v160, v171, v5
    v_and_b32 v161, v171, v6
    v_and_b32 v162, v171, v7
    v_and_b32 v163, v171, v8
    v_cndmask_b32 v171, v118, v119, s[54:55]
    v_and_b32 v164, v171, v5
    v_and_b32 v165, v171, v6
    v_and_b32 v166, v171, v7
    v_and_b32 v167, v171, v8
    s_cmp_eq_u32 s4, 4
    s_cbranch_scc1 L_pvw4_1
    s_waitcnt vmcnt(12)
    s_branch L_pvwd_1
L_pvw4_1:
    s_waitcnt vmcnt(18)
L_pvwd_1:
    v_mfma_f32_16x16x32_bf16 v[136:139], v[40:43], v[144:147], v[136:139]
    v_mfma_f32_16x16x32_bf16 v[140:143], v[56:59], v[160:163], v[140:143]
    v_mfma_f32_16x16x32_bf16 v[136:139], v[44:47], v[148:151], v[136:139]
    v_mfma_f32_16x16x32_bf16 v[140:143], v[60:63], v[164:167], v[140:143]
    v_mfma_f32_16x16x32_bf16 v[136:139], v[48:51], v[152:155], v[136:139]
    v_mfma_f32_16x16x32_bf16 v[136:139], v[52:55], v[156:159], v[136:139]
    v_and_b32 v144, v120, v5
    v_and_b32 v145, v120, v6
    v_and_b32 v146, v120, v7
    v_and_b32 v147, v120, v8
    v_and_b32 v148, v121, v5
    v_and_b32 v149, v121, v6
    v_and_b32 v150, v121, v7
    v_and_b32 v151, v121, v8
    v_and_b32 v152, v122, v5
    v_and_b32 v153, v122, v6
    v_and_b32 v154, v122, v7
    v_and_b32 v155, v122, v8
    v_and_b32 v156, v123, v5
    v_and_b32 v157, v123, v6
    v_and_b32 v158, v123, v7
    v_and_b32 v159, v123, v8
    v_cndmask_b32 v171, v120, v121, s[54:55]
    v_and_b32 v160, v171, v5
    v_and_b32 v161, v171, v6
    v_and_b32 v162, v171, v7
    v_and_b32 v163, v171, v8
    v_cndmask_b32 v171, v122, v123, s[54:55]
    v_and_b32 v164, v171, v5
    v_and_b32 v165, v171, v6
    v_and_b32 v166, v171, v7
    v_and_b32 v167, v171, v8
    s_cmp_eq_u32 s4, 4
    s_cbranch_scc1 L_pvw4_2
    s_waitcnt vmcnt(6)
    s_branch L_pvwd_2
L_pvw4_2:
    s_waitcnt vmcnt(12)
L_pvwd_2:
    v_mfma_f32_16x16x32_bf16 v[136:139], v[64:67], v[144:147], v[136:139]
    v_mfma_f32_16x16x32_bf16 v[140:143], v[80:83], v[160:163], v[140:143]
    v_mfma_f32_16x16x32_bf16 v[136:139], v[68:71], v[148:151], v[136:139]
    v_mfma_f32_16x16x32_bf16 v[140:143], v[84:87], v[164:167], v[140:143]
    v_mfma_f32_16x16x32_bf16 v[136:139], v[72:75], v[152:155], v[136:139]
    v_mfma_f32_16x16x32_bf16 v[136:139], v[76:79], v[156:159], v[136:139]
    v_and_b32 v144, v124, v5
    v_and_b32 v145, v124, v6
    v_and_b32 v146, v124, v7
    v_and_b32 v147, v124, v8
    v_and_b32 v148, v125, v5
    v_and_b32 v149, v125, v6
    v_and_b32 v150, v125, v7
    v_and_b32 v151, v125, v8
    v_and_b32 v152, v126, v5
    v_and_b32 v153, v126, v6
    v_and_b32 v154, v126, v7
    v_and_b32 v155, v126, v8
    v_and_b32 v156, v127, v5
    v_and_b32 v157, v127, v6
    v_and_b32 v158, v127, v7
    v_and_b32 v159, v127, v8
    v_cndmask_b32 v171, v124, v125, s[54:55]
    v_and_b32 v160, v171, v5
    v_and_b32 v161, v171, v6
    v_and_b32 v162, v171, v7
    v_and_b32 v163, v171, v8
    v_cndmask_b32 v171, v126, v127, s[54:55]
    v_and_b32 v164, v171, v5
    v_and_b32 v165, v171, v6
    v_and_b32 v166, v171, v7
    v_and_b32 v167, v171, v8
    s_cmp_eq_u32 s4, 4
    s_cbranch_scc1 L_pvw4_3
    s_waitcnt vmcnt(0)
    s_branch L_pvwd_3
L_pvw4_3:
    s_waitcnt vmcnt(6)
L_pvwd_3:
    v_mfma_f32_16x16x32_bf16 v[136:139], v[88:91], v[144:147], v[136:139]
    v_mfma_f32_16x16x32_bf16 v[140:143], v[104:107], v[160:163], v[140:143]
    v_mfma_f32_16x16x32_bf16 v[136:139], v[92:95], v[148:151], v[136:139]
    v_mfma_f32_16x16x32_bf16 v[140:143], v[108:111], v[164:167], v[140:143]
    v_mfma_f32_16x16x32_bf16 v[136:139], v[96:99], v[152:155], v[136:139]
    v_mfma_f32_16x16x32_bf16 v[136:139], v[100:103], v[156:159], v[136:139]
    s_nop 7
    v_mul_f32 v136, v136, v174
    v_mul_f32 v137, v137, v174
    v_mul_f32 v138, v138, v174
    v_mul_f32 v139, v139, v174
    v_mul_f32 v140, v140, v174
    v_mul_f32 v141, v141, v174
    v_mul_f32 v142, v142, v174
    v_mul_f32 v143, v143, v174
    v_mov_b32_dpp v144, v140 row_ror:8 row_mask:0xf bank_mask:0xf
    v_mov_b32_dpp v145, v141 row_ror:8 row_mask:0xf bank_mask:0xf
    v_mov_b32_dpp v146, v142 row_ror:8 row_mask:0xf bank_mask:0xf
    v_mov_b32_dpp v147, v143 row_ror:8 row_mask:0xf bank_mask:0xf
    v_permlane32_swap_b32 v144, v148
    v_permlane32_swap_b32 v145, v149
    v_permlane32_swap_b32 v146, v150
    v_permlane32_swap_b32 v147, v151
    s_mov_b32 exec_lo, 0x00ff00ff
    s_mov_b32 exec_hi, 0x00ff00ff
    ds_write_b32 v176, v136 offset:36864
    ds_write_b32 v176, v137 offset:37120
    ds_write_b32 v176, v138 offset:37376
    ds_write_b32 v176, v139 offset:37632
    v_add_f32 v140, v140, v148
    v_add_f32 v141, v141, v149
    v_add_f32 v142, v142, v150
    v_add_f32 v143, v143, v151
    s_mov_b32 exec_hi, 0
    ds_write_b32 v176, v140 offset:40960
    ds_write_b32 v176, v141 offset:41216
    ds_write_b32 v176, v142 offset:41472
    ds_write_b32 v176, v143 offset:41728
    s_mov_b64 exec, 1
    ds_write_b32 v177, v228 offset:43008
    s_mov_b64 exec, -1
    s_cmp_ge_u32 s4, 4
    s_cbranch_scc1 L_nowo
    s_setprio 0
    s_cmp_lt_u32 s4, 3
    s_cbranch_scc0 L_nol2
    v_lshlrev_b32 v171, 4, v0
    v_mov_b32 v172, 0
    ds_read_b128 v[192:195], v171 offset:16384
    ds_read_b128 v[204:207], v171 offset:19456
    ds_read_b128 v[216:219], v171 offset:22528
    ds_read_b128 v[196:199], v171 offset:17408
    ds_read_b128 v[208:211], v171 offset:20480
    ds_read_b128 v[220:223], v171 offset:23552
    ds_read_b128 v[200:203], v171 offset:18432
    ds_read_b128 v[212:215], v171 offset:21504
    ds_read_b128 v[224:227], v171 offset:24576
    ds_read_b32 v230, v172 offset:25600
    s_waitcnt lgkmcnt(0)
    s_mov_b32 s54, 0xbdd2d3e8
    s_mov_b32 s55, 0xbdd2d3e8
    s_mov_b32 s56, 1.0
    s_mov_b32 s57, 1.0
    v_mov_b32 v12, 0xc0135761
    v_mov_b32 v13, 0xc0135761
    s_mul_i32 s59, s4, 2
    s_add_u32 s59, s59, 10
    s_add_u32 s60, s59, 2
L_tl2:
    s_lshl_b32 s52, s2, 4
    s_add_u32 s52, s52, s59
    s_lshr_b32 s53, s52, 11
    s_lshl_b32 s53, s53, 31
    s_and_b32 s52, s52, 2047
    s_add_u32 s52, s52, 14592
    s_lshl_b32 s52, s52, 16
    s_or_b32 s50, s52, s53
    s_mov_b32 s51, s50
    s_call_b64 s[62:63], L_entry
    s_and_b32 s52, s92, 0xffff
    v_or_b32 v168, s52, v168
    v_mov_b32 v169, s92
    s_lshl_b32 s52, s2, 4
    s_add_u32 s52, s52, s59
    s_lshl_b32 s52, s52, 3
    s_add_u32 s52, s52, 1335296
    v_mov_b32 v170, 0
    s_mov_b64 exec, 1
    buffer_store_dwordx2 v[168:169], v170, s[20:23], s52 offen sc1
    s_mov_b64 exec, -1
    s_add_u32 s59, s59, 1
    s_cmp_lt_u32 s59, s60
    s_cbranch_scc1 L_tl2
L_nol2:
    s_cmp_le_u32 s4, 3
    s_cbranch_scc0 L_nowo
    v_mov_b32 v172, 0
    s_mov_b32 s58, 0
L_vw:
    ds_read_b32 v171, v172 offset:8716
    s_waitcnt lgkmcnt(0)
    v_readfirstlane_b32 s52, v171
    s_nop 0
    s_cmp_ge_u32 s52, 4
    s_cbranch_scc1 L_vw_ok
    s_sleep 1
    s_add_u32 s58, s58, 1
    s_cmp_lt_u32 s58, 524288
    s_cbranch_scc1 L_vw
L_vw_ok:
    s_mul_i32 s52, s5, 192
    s_mul_i32 s53, s6, 24
    s_add_u32 s52, s52, s53
    s_mul_i32 s52, s52, 1280
    s_lshl_b32 s53, s4, 8
    s_add_u32 s52, s52, s53
    v_mul_u32_u24 v171, 1280, v2
    v_lshl_add_u32 v171, v1, 4, v171
    buffer_load_dwordx4 v[204:207], v171, s[28:31], s52 offen nt
    s_add_u32 s52, s52, 5120
    buffer_load_dwordx4 v[208:211], v171, s[28:31], s52 offen nt
    s_add_u32 s52, s52, 5120
    buffer_load_dwordx4 v[212:215], v171, s[28:31], s52 offen nt
    s_add_u32 s52, s52, 5120
    buffer_load_dwordx4 v[216:219], v171, s[28:31], s52 offen nt
    s_add_u32 s52, s52, 5120
    buffer_load_dwordx4 v[220:223], v171, s[28:31], s52 offen nt
    s_add_u32 s52, s52, 5120
    buffer_load_dwordx4 v[224:227], v171, s[28:31], s52 offen nt
L_nowo:
    s_setprio 3
    s_waitcnt lgkmcnt(0)
    s_barrier
L_tail_begin:
    s_cmp_le_u32 s4, 4
    s_cbranch_scc0 L_hi
    s_mov_b32 s54, 0xaaaaaaaa
    s_mov_b32 s55, 0xaaaaaaaa
    v_mov_b32 v136, 0
    v_mov_b32 v137, 0
    v_mov_b32 v138, 0
    v_mov_b32 v139, 0
    s_mov_b32 s58, 0
L_apoll:
    buffer_load_dwordx4 v[176:179], v232, s[20:23], s94 offen sc1
    s_waitcnt vmcnt(0)
    v_bitop3_b32 v172, v176, v177, s9 bitop3:0x7e
    v_bitop3_b32 v173, v178, v179, s9 bitop3:0x7e
    v_bitop3_b32 v172, v172, v173, v15 bitop3:0x54
    v_cmp_ne_u32 vcc, 0, v172
    s_cbranch_vccz L_apoll_ok
    s_mov_b64 exec, vcc
    s_add_u32 s58, s58, 1
    s_cmp_lt_u32 s58, 32768
    s_cbranch_scc1 L_apoll
L_apoll_ok:
    s_mov_b64 exec, -1
    v_and_b32 v179, v15, v179
    s_nop 1
    v_mov_b32_dpp v180, v179 quad_perm:[1,0,3,2] row_mask:0xf bank_mask:0xf
    v_cndmask_b32 v181, v179, v180, s[54:55]
    v_cndmask_b32 v182, v180, v179, s[54:55]
    v_mov_b32 v183, v181
    s_nop 1
    v_max_f32_dpp v183, v183, v183 row_ror:2 row_mask:0xf bank_mask:0xf
    s_nop 1
    v_max_f32_dpp v183, v183, v183 row_ror:4 row_mask:0xf bank_mask:0xf
    s_nop 1
    v_max_f32_dpp v183, v183, v183 row_ror:8 row_mask:0xf bank_mask:0xf
    v_sub_f32 v181, v181, v183
    v_mul_f32 v181, 0x3fb8aa3b, v181
    v_exp_f32 v181, v181
    s_nop 0
    v_mul_f32 v176, v176, v181
    v_mul_f32 v177, v177, v181
    v_mul_f32 v178, v178, v181
    v_mul_f32 v182, v182, v181
    v_add_f32_dpp v176, v176, v176 row_ror:2 row_mask:0xf bank_mask:0xf
    v_add_f32_dpp v177, v177, v177 row_ror:2 row_mask:0xf bank_mask:0xf
    v_add_f32_dpp v178, v178, v178 row_ror:2 row_mask:0xf bank_mask:0xf
    v_add_f32_dpp v182, v182, v182 row_ror:2 row_mask:0xf bank_mask:0xf
    v_add_f32_dpp v176, v176, v176 row_ror:4 row_mask:0xf bank_mask:0xf
    v_add_f32_dpp v177, v177, v177 row_ror:4 row_mask:0xf bank_mask:0xf
    v_add_f32_dpp v178, v178, v178 row_ror:4 row_mask:0xf bank_mask:0xf
    v_add_f32_dpp v182, v182, v182 row_ror:4 row_mask:0xf bank_mask:0xf
    v_add_f32_dpp v176, v176, v176 row_ror:8 row_mask:0xf bank_mask:0xf
    v_add_f32_dpp v177, v177, v177 row_ror:8 row_mask:0xf bank_mask:0xf
    v_add_f32_dpp v178, v178, v178 row_ror:8 row_mask:0xf bank_mask:0xf
    v_add_f32_dpp v182, v182, v182 row_ror:8 row_mask:0xf bank_mask:0xf
    v_rcp_f32 v183, v182
    s_nop 0
    v_mul_f32 v176, v176, v183
    v_mul_f32 v177, v177, v183
    v_mul_f32 v178, v178, v183
    v_cvt_pk_bf16_f32 v176, v176, v176
    v_cvt_pk_bf16_f32 v177, v177, v177
    v_cvt_pk_bf16_f32 v178, v178, v178
    v_mov_b32_dpp v180, v176 quad_perm:[1,0,3,2] row_mask:0xf bank_mask:0xf
    v_mov_b32_dpp v181, v177 quad_perm:[1,0,3,2] row_mask:0xf bank_mask:0xf
    v_mov_b32_dpp v182, v178 quad_perm:[1,0,3,2] row_mask:0xf bank_mask:0xf
    v_cndmask_b32 v186, v176, v180, s[54:55]
    v_cndmask_b32 v189, v180, v176, s[54:55]
    v_cndmask_b32 v187, v177, v181, s[54:55]
    v_cndmask_b32 v190, v181, v177, s[54:55]
    v_cndmask_b32 v188, v178, v182, s[54:55]
    v_cndmask_b32 v191, v182, v178, s[54:55]
    v_and_b32 v144, v186, v5
    v_and_b32 v145, v186, v6
    v_and_b32 v146, v186, v7
    v_and_b32 v147, v186, v8
    v_and_b32 v148, v187, v5
    v_and_b32 v149, v187, v6
    v_and_b32 v150, v187, v7
    v_and_b32 v151, v187, v8
    v_and_b32 v152, v188, v5
    v_and_b32 v153, v188, v6
    v_and_b32 v154, v188, v7
    v_and_b32 v155, v188, v8
    v_and_b32 v156, v189, v5
    v_and_b32 v157, v189, v6
    v_and_b32 v158, v189, v7
    v_and_b32 v159, v189, v8
    v_and_b32 v160, v190, v5
    v_and_b32 v161, v190, v6
    v_and_b32 v162, v190, v7
    v_and_b32 v163, v190, v8
    v_and_b32 v164, v191, v5
    v_and_b32 v165, v191, v6
    v_and_b32 v166, v191, v7
    v_and_b32 v167, v191, v8
    v_mfma_f32_16x16x32_bf16 v[136:139], v[204:207], v[144:147], v[136:139]
    v_mfma_f32_16x16x32_bf16 v[136:139], v[208:211], v[148:151], v[136:139]
    v_mfma_f32_16x16x32_bf16 v[136:139], v[212:215], v[152:155], v[136:139]
    v_mfma_f32_16x16x32_bf16 v[136:139], v[216:219], v[156:159], v[136:139]
    v_mfma_f32_16x16x32_bf16 v[136:139], v[220:223], v[160:163], v[136:139]
    v_mfma_f32_16x16x32_bf16 v[136:139], v[224:227], v[164:167], v[136:139]
    s_mov_b32 exec_lo, 0x00ff00ff
    s_mov_b32 exec_hi, 0x00ff00ff
    s_nop 5
    v_and_or_b32 v136, v136, v15, s9
    v_and_or_b32 v137, v137, v15, s9
    v_and_or_b32 v138, v138, v15, s9
    v_and_or_b32 v139, v139, v15, s9
    s_cmp_eq_u32 s11, 1
    s_cbranch_scc1 L_py_f
    buffer_store_dwordx4 v[136:139], v233, s[20:23], s95 offen sc1
    s_branch L_py_d
L_py_f:
    buffer_store_dwordx4 v[136:139], v233, s[20:23], s95 offen
L_py_d:
    s_mov_b32 exec_lo, -1
    s_mov_b32 exec_hi, 0
    s_mov_b32 s58, 0
L_ypoll:
    buffer_load_dwordx4 v[176:179], v234, s[20:23], s96 offen sc1
    s_waitcnt vmcnt(0)
    v_bitop3_b32 v172, v176, v177, s9 bitop3:0x7e
    v_bitop3_b32 v173, v178, v179, s9 bitop3:0x7e
    v_bitop3_b32 v172, v172, v173, v15 bitop3:0x54
    v_cmp_ne_u32 vcc, 0, v172
    s_cbranch_vccz L_ypoll_ok
    s_mov_b64 exec, vcc
    s_add_u32 s58, s58, 1
    s_cmp_lt_u32 s58, 32768
    s_cbranch_scc1 L_ypoll
L_ypoll_ok:
    s_mov_b64 exec, -1
    v_add_f32_dpp v176, v176, v176 row_ror:8 row_mask:0xf bank_mask:0xf
    v_add_f32_dpp v177, v177, v177 row_ror:8 row_mask:0xf bank_mask:0xf
    v_add_f32_dpp v178, v178, v178 row_ror:8 row_mask:0xf bank_mask:0xf
    v_add_f32_dpp v179, v179, v179 row_ror:8 row_mask:0xf bank_mask:0xf
    v_add_f32_dpp v176, v176, v176 row_ror:4 row_mask:0xf bank_mask:0xf
    v_add_f32_dpp v177, v177, v177 row_ror:4 row_mask:0xf bank_mask:0xf
    v_add_f32_dpp v178, v178, v178 row_ror:4 row_mask:0xf bank_mask:0xf
    v_add_f32_dpp v179, v179, v179 row_ror:4 row_mask:0xf bank_mask:0xf
    v_add_f32_dpp v176, v176, v176 row_ror:2 row_mask:0xf bank_mask:0xf
    v_add_f32_dpp v177, v177, v177 row_ror:2 row_mask:0xf bank_mask:0xf
    v_add_f32_dpp v178, v178, v178 row_ror:2 row_mask:0xf bank_mask:0xf
    v_add_f32_dpp v179, v179, v179 row_ror:2 row_mask:0xf bank_mask:0xf
    v_add_f32_dpp v176, v176, v176 row_ror:1 row_mask:0xf bank_mask:0xf
    v_add_f32_dpp v177, v177, v177 row_ror:1 row_mask:0xf bank_mask:0xf
    v_add_f32_dpp v178, v178, v178 row_ror:1 row_mask:0xf bank_mask:0xf
    v_add_f32_dpp v179, v179, v179 row_ror:1 row_mask:0xf bank_mask:0xf
    v_mov_b32 v180, v176
    v_mov_b32 v181, v177
    v_mov_b32 v182, v178
    v_mov_b32 v183, v179
    v_permlane16_swap_b32 v176, v180
    v_permlane16_swap_b32 v177, v181
    v_permlane16_swap_b32 v178, v182
    v_permlane16_swap_b32 v179, v183
    v_add_f32 v176, v176, v180
    v_add_f32 v177, v177, v181
    v_add_f32 v178, v178, v182
    v_add_f32 v179, v179, v183
    s_mov_b64 exec, 1
    v_and_or_b32 v176, v176, v15, s9
    v_and_or_b32 v177, v177, v15, s9
    v_and_or_b32 v178, v178, v15, s9
    v_and_or_b32 v179, v179, v15, s9
    buffer_store_dwordx4 v[176:179], v235, s[20:23], s97 offen sc1
    s_mov_b64 exec, -1
    s_branch L_done
L_hi:
    s_cmp_eq_u32 s4, 7
    s_cbranch_scc0 L_nopub
    ds_read_b128 v[16:19], v184 offset:36864
    ds_read_b128 v[20:23], v184 offset:36880
    ds_read_b128 v[24:27], v184 offset:36992
    ds_read_b128 v[28:31], v184 offset:37008
    ds_read_b128 v[32:35], v184 offset:37120
    ds_read_b128 v[36:39], v184 offset:37136
    ds_read_b128 v[40:43], v185 offset:43008
    ds_read_b128 v[44:47], v185 offset:43024
    s_mov_b32 vcc_lo, 0xaaaaaaaa
    s_mov_b32 vcc_hi, 0xaaaaaaaa
    s_waitcnt lgkmcnt(0)
    v_pk_add_f32 v[16:17], v[16:17], v[18:19]
    v_pk_add_f32 v[20:21], v[20:21], v[22:23]
    v_pk_add_f32 v[24:25], v[24:25], v[26:27]
    v_pk_add_f32 v[28:29], v[28:29], v[30:31]
    v_pk_add_f32 v[32:33], v[32:33], v[34:35]
    v_pk_add_f32 v[36:37], v[36:37], v[38:39]
    v_pk_add_f32 v[40:41], v[40:41], v[42:43]
    v_pk_add_f32 v[44:45], v[44:45], v[46:47]
    v_pk_add_f32 v[16:17], v[16:17], v[20:21]
    v_pk_add_f32 v[24:25], v[24:25], v[28:29]
    v_pk_add_f32 v[32:33], v[32:33], v[36:37]
    v_pk_add_f32 v[40:41], v[40:41], v[44:45]
    v_add_f32 v176, v16, v17
    v_add_f32 v177, v24, v25
    v_add_f32 v178, v32, v33
    v_add_f32 v179, v40, v41
    v_cndmask_b32 v179, v175, v179, vcc
    v_and_or_b32 v176, v176, v15, s9
    v_and_or_b32 v177, v177, v15, s9
    v_and_or_b32 v178, v178, v15, s9
    v_and_or_b32 v179, v179, v15, s9
    s_cmp_eq_u32 s11, 1
    s_cbranch_scc1 L_pa_f
    buffer_store_dwordx4 v[176:179], v186, s[20:23], s98 offen sc1
    s_branch L_pa_d
L_pa_f:
    buffer_store_dwordx4 v[176:179], v186, s[20:23], s98 offen
L_pa_d:
L_nopub:
    s_cmp_eq_u32 s2, 0
    s_cbranch_scc0 L_done
    s_cmp_eq_u32 s4, 7
    s_cbranch_scc1 L_notg
    s_sub_u32 s52, s4, 5
    s_lshl_b32 s52, s52, 14
    s_add_u32 s52, s52, 1335296
    v_lshlrev_b32 v171, 4, v0
    v_mov_b32 v14, 0xffff
    s_mov_b32 s58, 0
L_tg:
    s_mov_b32 s53, s52
    buffer_load_dwordx4 v[16:19], v171, s[20:23], s53 offen offset:0 sc1
    buffer_load_dwordx4 v[20:23], v171, s[20:23], s53 offen offset:1024 sc1
    buffer_load_dwordx4 v[24:27], v171, s[20:23], s53 offen offset:2048 sc1
    buffer_load_dwordx4 v[28:31], v171, s[20:23], s53 offen offset:3072 sc1
    s_add_u32 s53, s53, 4096
    buffer_load_dwordx4 v[32:35], v171, s[20:23], s53 offen offset:0 sc1
    buffer_load_dwordx4 v[36:39], v171, s[20:23], s53 offen offset:1024 sc1
    buffer_load_dwordx4 v[40:43], v171, s[20:23], s53 offen offset:2048 sc1
    buffer_load_dwordx4 v[44:47], v171, s[20:23], s53 offen offset:3072 sc1
    s_add_u32 s53, s53, 4096
    buffer_load_dwordx4 v[48:51], v171, s[20:23], s53 offen offset:0 sc1
    buffer_load_dwordx4 v[52:55], v171, s[20:23], s53 offen offset:1024 sc1
    buffer_load_dwordx4 v[56:59], v171, s[20:23], s53 offen offset:2048 sc1
    buffer_load_dwordx4 v[60:63], v171, s[20:23], s53 offen offset:3072 sc1
    s_add_u32 s53, s53, 4096
    buffer_load_dwordx4 v[64:67], v171, s[20:23], s53 offen offset:0 sc1
    buffer_load_dwordx4 v[68:71], v171, s[20:23], s53 offen offset:1024 sc1
    buffer_load_dwordx4 v[72:75], v171, s[20:23], s53 offen offset:2048 sc1
    buffer_load_dwordx4 v[76:79], v171, s[20:23], s53 offen offset:3072 sc1
    s_waitcnt vmcnt(0)
    s_and_b32 s56, s92, 0xffff
    v_mov_b32 v172, 0
    v_xor_b32 v173, s92, v17
    v_xor_b32 v174, s92, v19
    v_or3_b32 v172, v172, v173, v174
    v_xor_b32 v173, s56, v16
    v_xor_b32 v174, s56, v18
    v_or_b32 v173, v173, v174
    v_and_or_b32 v172, v173, v14, v172
    v_xor_b32 v173, s92, v21
    v_xor_b32 v174, s92, v23
    v_or3_b32 v172, v172, v173, v174
    v_xor_b32 v173, s56, v20
    v_xor_b32 v174, s56, v22
    v_or_b32 v173, v173, v174
    v_and_or_b32 v172, v173, v14, v172
    v_xor_b32 v173, s92, v25
    v_xor_b32 v174, s92, v27
    v_or3_b32 v172, v172, v173, v174
    v_xor_b32 v173, s56, v24
    v_xor_b32 v174, s56, v26
    v_or_b32 v173, v173, v174
    v_and_or_b32 v172, v173, v14, v172
    v_xor_b32 v173, s92, v29
    v_xor_b32 v174, s92, v31
    v_or3_b32 v172, v172, v173, v174
    v_xor_b32 v173, s56, v28
    v_xor_b32 v174, s56, v30
    v_or_b32 v173, v173, v174
    v_and_or_b32 v172, v173, v14, v172
    v_xor_b32 v173, s92, v33
    v_xor_b32 v174, s92, v35
    v_or3_b32 v172, v172, v173, v174
    v_xor_b32 v173, s56, v32
    v_xor_b32 v174, s56, v34
    v_or_b32 v173, v173, v174
    v_and_or_b32 v172, v173, v14, v172
    v_xor_b32 v173, s92, v37
    v_xor_b32 v174, s92, v39
    v_or3_b32 v172, v172, v173, v174
    v_xor_b32 v173, s56, v36
    v_xor_b32 v174, s56, v38
    v_or_b32 v173, v173, v174
    v_and_or_b32 v172, v173, v14, v172
    v_xor_b32 v173, s92, v41
    v_xor_b32 v174, s92, v43
    v_or3_b32 v172, v172, v173, v174
    v_xor_b32 v173, s56, v40
    v_xor_b32 v174, s56, v42
    v_or_b32 v173, v173, v174
    v_and_or_b32 v172, v173, v14, v172
    v_xor_b32 v173, s92, v45
    v_xor_b32 v174, s92, v47
    v_or3_b32 v172, v172, v173, v174
    v_xor_b32 v173, s56, v44
    v_xor_b32 v174, s56, v46
    v_or_b32 v173, v173, v174
    v_and_or_b32 v172, v173, v14, v172
    v_xor_b32 v173, s92, v49
    v_xor_b32 v174, s92, v51
    v_or3_b32 v172, v172, v173, v174
    v_xor_b32 v173, s56, v48
    v_xor_b32 v174, s56, v50
    v_or_b32 v173, v173, v174
    v_and_or_b32 v172, v173, v14, v172
    v_xor_b32 v173, s92, v53
    v_xor_b32 v174, s92, v55
    v_or3_b32 v172, v172, v173, v174
    v_xor_b32 v173, s56, v52
    v_xor_b32 v174, s56, v54
    v_or_b32 v173, v173, v174
    v_and_or_b32 v172, v173, v14, v172
    v_xor_b32 v173, s92, v57
    v_xor_b32 v174, s92, v59
    v_or3_b32 v172, v172, v173, v174
    v_xor_b32 v173, s56, v56
    v_xor_b32 v174, s56, v58
    v_or_b32 v173, v173, v174
    v_and_or_b32 v172, v173, v14, v172
    v_xor_b32 v173, s92, v61
    v_xor_b32 v174, s92, v63
    v_or3_b32 v172, v172, v173, v174
    v_xor_b32 v173, s56, v60
    v_xor_b32 v174, s56, v62
    v_or_b32 v173, v173, v174
    v_and_or_b32 v172, v173, v14, v172
    v_xor_b32 v173, s92, v65
    v_xor_b32 v174, s92, v67
    v_or3_b32 v172, v172, v173, v174
    v_xor_b32 v173, s56, v64
    v_xor_b32 v174, s56, v66
    v_or_b32 v173, v173, v174
    v_and_or_b32 v172, v173, v14, v172
    v_xor_b32 v173, s92, v69
    v_xor_b32 v174, s92, v71
    v_or3_b32 v172, v172, v173, v174
    v_xor_b32 v173, s56, v68
    v_xor_b32 v174, s56, v70
    v_or_b32 v173, v173, v174
    v_and_or_b32 v172, v173, v14, v172
    v_xor_b32 v173, s92, v73
    v_xor_b32 v174, s92, v75
    v_or3_b32 v172, v172, v173, v174
    v_xor_b32 v173, s56, v72
    v_xor_b32 v174, s56, v74
    v_or_b32 v173, v173, v174
    v_and_or_b32 v172, v173, v14, v172
    v_xor_b32 v173, s92, v77
    v_xor_b32 v174, s92, v79
    v_or3_b32 v172, v172, v173, v174
    v_xor_b32 v173, s56, v76
    v_xor_b32 v174, s56, v78
    v_or_b32 v173, v173, v174
    v_and_or_b32 v172, v173, v14, v172
    v_cmp_ne_u32 vcc, 0, v172
    s_cbranch_vccz L_tg_ok
    s_add_u32 s58, s58, 1
    s_sleep 4
    s_cmp_lt_u32 s58, 32768
    s_cbranch_scc1 L_tg
L_tg_ok:
    s_mov_b32 s53, 94720
    s_cmp_eq_u32 s4, 5
    s_cselect_b32 s52, 29184, s53
    v_lshlrev_b32 v171, 2, v0
    v_add_u32 v171, s52, v171
    v_lshrrev_b32 v16, 16, v16
    v_and_b32 v18, 0xffff0000, v18
    v_or_b32 v16, v16, v18
    ds_write_b32 v171, v16 offset:0
    v_lshrrev_b32 v20, 16, v20
    v_and_b32 v22, 0xffff0000, v22
    v_or_b32 v20, v20, v22
    ds_write_b32 v171, v20 offset:256
    v_lshrrev_b32 v24, 16, v24
    v_and_b32 v26, 0xffff0000, v26
    v_or_b32 v24, v24, v26
    ds_write_b32 v171, v24 offset:512
    v_lshrrev_b32 v28, 16, v28
    v_and_b32 v30, 0xffff0000, v30
    v_or_b32 v28, v28, v30
    ds_write_b32 v171, v28 offset:768
    v_lshrrev_b32 v32, 16, v32
    v_and_b32 v34, 0xffff0000, v34
    v_or_b32 v32, v32, v34
    ds_write_b32 v171, v32 offset:1024
    v_lshrrev_b32 v36, 16, v36
    v_and_b32 v38, 0xffff0000, v38
    v_or_b32 v36, v36, v38
    ds_write_b32 v171, v36 offset:1280
    v_lshrrev_b32 v40, 16, v40
    v_and_b32 v42, 0xffff0000, v42
    v_or_b32 v40, v40, v42
    ds_write_b32 v171, v40 offset:1536
    v_lshrrev_b32 v44, 16, v44
    v_and_b32 v46, 0xffff0000, v46
    v_or_b32 v44, v44, v46
    ds_write_b32 v171, v44 offset:1792
    v_lshrrev_b32 v48, 16, v48
    v_and_b32 v50, 0xffff0000, v50
    v_or_b32 v48, v48, v50
    ds_write_b32 v171, v48 offset:2048
    v_lshrrev_b32 v52, 16, v52
    v_and_b32 v54, 0xffff0000, v54
    v_or_b32 v52, v52, v54
    ds_write_b32 v171, v52 offset:2304
    v_lshrrev_b32 v56, 16, v56
    v_and_b32 v58, 0xffff0000, v58
    v_or_b32 v56, v56, v58
    ds_write_b32 v171, v56 offset:2560
    v_lshrrev_b32 v60, 16, v60
    v_and_b32 v62, 0xffff0000, v62
    v_or_b32 v60, v60, v62
    ds_write_b32 v171, v60 offset:2816
    v_lshrrev_b32 v64, 16, v64
    v_and_b32 v66, 0xffff0000, v66
    v_or_b32 v64, v64, v66
    ds_write_b32 v171, v64 offset:3072
    v_lshrrev_b32 v68, 16, v68
    v_and_b32 v70, 0xffff0000, v70
    v_or_b32 v68, v68, v70
    ds_write_b32 v171, v68 offset:3328
    v_lshrrev_b32 v72, 16, v72
    v_and_b32 v74, 0xffff0000, v74
    v_or_b32 v72, v72, v74
    ds_write_b32 v171, v72 offset:3584
    v_lshrrev_b32 v76, 16, v76
    v_and_b32 v78, 0xffff0000, v78
    v_or_b32 v76, v76, v78
    ds_write_b32 v171, v76 offset:3840
L_notg:
    s_sub_u32 s52, s4, 5
    s_lshl_b32 s52, s52, 6
    v_add_u32 v11, s52, v0
    s_movk_i32 s52, 160
    v_cmp_gt_u32 vcc, s52, v11
    s_nop 0
    s_and_saveexec_b64 s[56:57], vcc
    v_lshlrev_b32 v171, 4, v11
    v_lshrrev_b32 v184, 3, v11
    v_lshlrev_b32 v184, 5, v184
    v_and_b32 v172, 7, v11
    v_add_u32 v184, v184, v172
    v_lshlrev_b32 v184, 2, v184
    ds_read_b32 v180, v184 offset:9984
    ds_read_b32 v181, v184 offset:10016
    ds_read_b32 v182, v184 offset:10048
    ds_read_b32 v183, v184 offset:10080
    s_mov_b32 s52, 1310720
    s_mov_b32 s53, 1315840
    s_mov_b32 s59, 1320960
    s_mov_b32 s60, 1326080
    s_mov_b32 s58, 0
L_bpoll:
    buffer_load_dwordx4 v[16:19], v171, s[20:23], s52 offen offset:0 sc1
    buffer_load_dwordx4 v[20:23], v171, s[20:23], s52 offen offset:2560 sc1
    buffer_load_dwordx4 v[24:27], v171, s[20:23], s53 offen offset:0 sc1
    buffer_load_dwordx4 v[28:31], v171, s[20:23], s53 offen offset:2560 sc1
    buffer_load_dwordx4 v[32:35], v171, s[20:23], s59 offen offset:0 sc1
    buffer_load_dwordx4 v[36:39], v171, s[20:23], s59 offen offset:2560 sc1
    buffer_load_dwordx4 v[40:43], v171, s[20:23], s60 offen offset:0 sc1
    buffer_load_dwordx4 v[44:47], v171, s[20:23], s60 offen offset:2560 sc1
    s_waitcnt vmcnt(0)
    v_bitop3_b32 v172, v16, v17, s9 bitop3:0x7e
    v_bitop3_b32 v173, v18, v19, s9 bitop3:0x7e
    v_or_b32 v172, v172, v173
    v_bitop3_b32 v173, v20, v21, s9 bitop3:0x7e
    v_bitop3_b32 v14, v22, v23, s9 bitop3:0x7e
    v_or3_b32 v172, v172, v173, v14
    v_bitop3_b32 v173, v24, v25, s9 bitop3:0x7e
    v_bitop3_b32 v14, v26, v27, s9 bitop3:0x7e
    v_or3_b32 v172, v172, v173, v14
    v_bitop3_b32 v173, v28, v29, s9 bitop3:0x7e
    v_bitop3_b32 v14, v30, v31, s9 bitop3:0x7e
    v_or3_b32 v172, v172, v173, v14
    v_bitop3_b32 v173, v32, v33, s9 bitop3:0x7e
    v_bitop3_b32 v14, v34, v35, s9 bitop3:0x7e
    v_or3_b32 v172, v172, v173, v14
    v_bitop3_b32 v173, v36, v37, s9 bitop3:0x7e
    v_bitop3_b32 v14, v38, v39, s9 bitop3:0x7e
    v_or3_b32 v172, v172, v173, v14
    v_bitop3_b32 v173, v40, v41, s9 bitop3:0x7e
    v_bitop3_b32 v14, v42, v43, s9 bitop3:0x7e
    v_or3_b32 v172, v172, v173, v14
    v_bitop3_b32 v173, v44, v45, s9 bitop3:0x7e
    v_bitop3_b32 v14, v46, v47, s9 bitop3:0x7e
    v_or3_b32 v172, v172, v173, v14
    v_bitop3_b32 v172, v172, v172, v15 bitop3:0x50
    v_cmp_ne_u32 vcc, 0, v172
    s_cbranch_vccz L_bpoll_ok
    s_add_u32 s58, s58, 1
    s_sleep 1
    s_cmp_lt_u32 s58, 32768
    s_cbranch_scc1 L_bpoll
L_bpoll_ok:
    v_pk_add_f32 v[16:17], v[16:17], v[20:21]
    v_pk_add_f32 v[24:25], v[24:25], v[28:29]
    v_pk_add_f32 v[32:33], v[32:33], v[36:37]
    v_pk_add_f32 v[40:41], v[40:41], v[44:45]
    v_pk_add_f32 v[18:19], v[18:19], v[22:23]
    v_pk_add_f32 v[26:27], v[26:27], v[30:31]
    v_pk_add_f32 v[34:35], v[34:35], v[38:39]
    v_pk_add_f32 v[42:43], v[42:43], v[46:47]
    v_pk_add_f32 v[16:17], v[16:17], v[24:25]
    v_pk_add_f32 v[32:33], v[32:33], v[40:41]
    v_pk_add_f32 v[18:19], v[18:19], v[26:27]
    v_pk_add_f32 v[34:35], v[34:35], v[42:43]
    v_pk_add_f32 v[16:17], v[16:17], v[32:33]
    v_pk_add_f32 v[18:19], v[18:19], v[34:35]
    v_cvt_pk_bf16_f32 v172, v16, v17
    v_lshlrev_b32 v16, 16, v172
    v_and_b32 v17, 0xffff0000, v172
    v_cvt_pk_bf16_f32 v173, v18, v19
    v_lshlrev_b32 v18, 16, v173
    v_and_b32 v19, 0xffff0000, v173
    s_waitcnt lgkmcnt(0)
    v_pk_add_f32 v[16:17], v[16:17], v[180:181]
    v_pk_add_f32 v[18:19], v[18:19], v[182:183]
    v_cvt_pk_bf16_f32 v172, v16, v17
    v_lshlrev_b32 v16, 16, v172
    v_and_b32 v17, 0xffff0000, v172
    v_cvt_pk_bf16_f32 v173, v18, v19
    v_lshlrev_b32 v18, 16, v173
    v_and_b32 v19, 0xffff0000, v173
    ds_write_b32 v184, v16 offset:12544
    ds_write_b32 v184, v17 offset:12576
    ds_write_b32 v184, v18 offset:12608
    ds_write_b32 v184, v19 offset:12640
    s_mov_b64 exec, s[56:57]
    s_waitcnt lgkmcnt(0)
    s_barrier
    s_cmp_eq_u32 s4, 6
    s_cbranch_scc0 L_nobump
    v_mov_b32 v172, s92
    v_mov_b32 v173, 0
    s_mov_b64 exec, 1
    buffer_store_dword v172, v173, s[20:23], 0 offen sc1
    s_mov_b64 exec, -1
L_nobump:
    s_cmp_eq_u32 s4, 5
    s_cbranch_scc0 L_done
    v_lshlrev_b32 v171, 3, v0
    ds_read_b64 v[16:17], v171 offset:12544
    ds_read_b64 v[18:19], v171 offset:13056
    ds_read_b64 v[20:21], v171 offset:13568
    ds_read_b64 v[22:23], v171 offset:14080
    ds_read_b64 v[24:25], v171 offset:14592
    v_mov_b32 v56, 0
    v_mov_b32 v57, 0
    v_mov_b32 v58, 0
    v_mov_b32 v59, 0
    v_mov_b32 v60, 0
    v_mov_b32 v61, 0
    v_mov_b32 v62, 0
    v_mov_b32 v63, 0
    v_mov_b32 v64, 0
    v_mov_b32 v65, 0
    s_waitcnt lgkmcnt(0)
    v_readfirstlane_b32 s50, v16
    s_nop 0
    s_mov_b32 s51, s50
    v_pk_add_f32 v[26:27], v[16:17], s[50:51] neg_lo:[0,1] neg_hi:[0,1]
    v_pk_add_f32 v[28:29], v[18:19], s[50:51] neg_lo:[0,1] neg_hi:[0,1]
    v_pk_add_f32 v[30:31], v[20:21], s[50:51] neg_lo:[0,1] neg_hi:[0,1]
    v_pk_add_f32 v[32:33], v[22:23], s[50:51] neg_lo:[0,1] neg_hi:[0,1]
    v_pk_add_f32 v[34:35], v[24:25], s[50:51] neg_lo:[0,1] neg_hi:[0,1]
    v_pk_add_f32 v[36:37], v[26:27], v[28:29]
    v_pk_mul_f32 v[38:39], v[26:27], v[26:27]
    v_pk_add_f32 v[40:41], v[30:31], v[32:33]
    v_pk_fma_f32 v[38:39], v[28:29], v[28:29], v[38:39]
    v_pk_add_f32 v[36:37], v[36:37], v[34:35]
    v_pk_fma_f32 v[38:39], v[30:31], v[30:31], v[38:39]
    v_pk_add_f32 v[36:37], v[36:37], v[40:41]
    v_pk_fma_f32 v[38:39], v[32:33], v[32:33], v[38:39]
    v_pk_fma_f32 v[38:39], v[34:35], v[34:35], v[38:39]
    v_add_f32 v168, v36, v37
    v_add_f32 v169, v38, v39
    s_nop 0
    v_add_f32_dpp v168, v168, v168 row_ror:8 row_mask:0xf bank_mask:0xf
    v_add_f32_dpp v169, v169, v169 row_ror:8 row_mask:0xf bank_mask:0xf
    s_nop 0
    v_add_f32_dpp v168, v168, v168 row_ror:4 row_mask:0xf bank_mask:0xf
    v_add_f32_dpp v169, v169, v169 row_ror:4 row_mask:0xf bank_mask:0xf
    s_nop 0
    v_add_f32_dpp v168, v168, v168 row_ror:2 row_mask:0xf bank_mask:0xf
    v_add_f32_dpp v169, v169, v169 row_ror:2 row_mask:0xf bank_mask:0xf
    s_nop 0
    v_add_f32_dpp v168, v168, v168 row_ror:1 row_mask:0xf bank_mask:0xf
    v_add_f32_dpp v169, v169, v169 row_ror:1 row_mask:0xf bank_mask:0xf
    v_mov_b32 v171, v168
    v_mov_b32 v172, v169
    s_nop 0
    v_permlane16_swap_b32 v168, v171
    v_permlane16_swap_b32 v169, v172
    v_add_f32 v168, v168, v171
    v_add_f32 v169, v169, v172
    v_mov_b32 v171, v168
    v_mov_b32 v172, v169
    s_nop 0
    v_permlane32_swap_b32 v168, v171
    v_permlane32_swap_b32 v169, v172
    v_add_f32 v168, v168, v171
    v_add_f32 v169, v169, v172
    v_mul_f32 v168, 0x3acccccd, v168
    v_mul_f32 v169, 0x3acccccd, v169
    v_fma_f32 v169, -v168, v168, v169
    v_add_f32 v168, s50, v168
    v_max_f32 v169, 0, v169
    v_cvt_pk_bf16_f32 v171, v168, v169
    v_lshlrev_b32 v168, 16, v171
    v_and_b32 v169, 0xffff0000, v171
    v_add_f32 v169, 0x3727c5ac, v169
    v_cvt_pk_bf16_f32 v171, v169, v169
    v_lshlrev_b32 v169, 16, v171
    v_sqrt_f32 v169, v169
    s_nop 0
    v_cvt_pk_bf16_f32 v171, v169, v169
    v_lshlrev_b32 v169, 16, v171
    v_rcp_f32 v170, v169
    v_pk_add_f32 v[26:27], v[16:17], v[168:169] op_sel_hi:[1,0] neg_lo:[0,1] neg_hi:[0,1]
    v_pk_add_f32 v[28:29], v[18:19], v[168:169] op_sel_hi:[1,0] neg_lo:[0,1] neg_hi:[0,1]
    v_pk_add_f32 v[30:31], v[20:21], v[168:169] op_sel_hi:[1,0] neg_lo:[0,1] neg_hi:[0,1]
    v_pk_add_f32 v[32:33], v[22:23], v[168:169] op_sel_hi:[1,0] neg_lo:[0,1] neg_hi:[0,1]
    v_pk_add_f32 v[34:35], v[24:25], v[168:169] op_sel_hi:[1,0] neg_lo:[0,1] neg_hi:[0,1]
    v_cvt_pk_bf16_f32 v50, v26, v27
    v_cvt_pk_bf16_f32 v51, v28, v29
    v_cvt_pk_bf16_f32 v52, v30, v31
    v_cvt_pk_bf16_f32 v53, v32, v33
    v_cvt_pk_bf16_f32 v54, v34, v35
    v_lshlrev_b32 v26, 16, v50
    v_and_b32 v27, 0xffff0000, v50
    v_lshlrev_b32 v28, 16, v51
    v_and_b32 v29, 0xffff0000, v51
    v_lshlrev_b32 v30, 16, v52
    v_and_b32 v31, 0xffff0000, v52
    v_lshlrev_b32 v32, 16, v53
    v_and_b32 v33, 0xffff0000, v53
    v_lshlrev_b32 v34, 16, v54
    v_and_b32 v35, 0xffff0000, v54
    v_pk_mul_f32 v[26:27], v[26:27], v[170:171] op_sel_hi:[1,0]
    v_pk_mul_f32 v[28:29], v[28:29], v[170:171] op_sel_hi:[1,0]
    v_pk_mul_f32 v[30:31], v[30:31], v[170:171] op_sel_hi:[1,0]
    v_pk_mul_f32 v[32:33], v[32:33], v[170:171] op_sel_hi:[1,0]
    v_pk_mul_f32 v[34:35], v[34:35], v[170:171] op_sel_hi:[1,0]
    v_cvt_pk_bf16_f32 v50, v26, v27
    v_cvt_pk_bf16_f32 v51, v28, v29
    v_cvt_pk_bf16_f32 v52, v30, v31
    v_cvt_pk_bf16_f32 v53, v32, v33
    v_cvt_pk_bf16_f32 v54, v34, v35
    v_mov_b32 v168, 0
    v_mov_b32 v169, 0
    v_mov_b32 v173, 0x3f803f80
    v_dot2c_f32_bf16 v168, v50, v173
    v_dot2c_f32_bf16 v169, v50, v50
    v_dot2c_f32_bf16 v168, v51, v173
    v_dot2c_f32_bf16 v169, v51, v51
    v_dot2c_f32_bf16 v168, v52, v173
    v_dot2c_f32_bf16 v169, v52, v52
    v_dot2c_f32_bf16 v168, v53, v173
    v_dot2c_f32_bf16 v169, v53, v53
    v_dot2c_f32_bf16 v168, v54, v173
    v_dot2c_f32_bf16 v169, v54, v54
    v_lshlrev_b32 v26, 16, v50
    v_and_b32 v27, 0xffff0000, v50
    v_lshlrev_b32 v28, 16, v51
    v_and_b32 v29, 0xffff0000, v51
    v_lshlrev_b32 v30, 16, v52
    v_and_b32 v31, 0xffff0000, v52
    v_lshlrev_b32 v32, 16, v53
    v_and_b32 v33, 0xffff0000, v53
    v_lshlrev_b32 v34, 16, v54
    v_and_b32 v35, 0xffff0000, v54
    v_add_f32_dpp v168, v168, v168 row_ror:8 row_mask:0xf bank_mask:0xf
    v_add_f32_dpp v169, v169, v169 row_ror:8 row_mask:0xf bank_mask:0xf
    s_nop 0
    v_add_f32_dpp v168, v168, v168 row_ror:4 row_mask:0xf bank_mask:0xf
    v_add_f32_dpp v169, v169, v169 row_ror:4 row_mask:0xf bank_mask:0xf
    s_nop 0
    v_add_f32_dpp v168, v168, v168 row_ror:2 row_mask:0xf bank_mask:0xf
    v_add_f32_dpp v169, v169, v169 row_ror:2 row_mask:0xf bank_mask:0xf
    s_nop 0
    v_add_f32_dpp v168, v168, v168 row_ror:1 row_mask:0xf bank_mask:0xf
    v_add_f32_dpp v169, v169, v169 row_ror:1 row_mask:0xf bank_mask:0xf
    v_mov_b32 v171, v168
    v_mov_b32 v172, v169
    s_nop 0
    v_permlane16_swap_b32 v168, v171
    v_permlane16_swap_b32 v169, v172
    v_add_f32 v168, v168, v171
    v_add_f32 v169, v169, v172
    v_mov_b32 v171, v168
    v_mov_b32 v172, v169
    s_nop 0
    v_permlane32_swap_b32 v168, v171
    v_permlane32_swap_b32 v169, v172
    v_add_f32 v168, v168, v171
    v_add_f32 v169, v169, v172
    v_mul_f32 v168, 0x3acccccd, v168
    v_mul_f32 v169, 0x3acccccd, v169
    v_fma_f32 v169, -v168, v168, v169
    v_max_f32 v169, 0, v169
    v_cvt_pk_bf16_f32 v171, v168, v169
    v_lshlrev_b32 v168, 16, v171
    v_and_b32 v169, 0xffff0000, v171
    v_add_f32 v169, 0x3727c5ac, v169
    v_cvt_pk_bf16_f32 v171, v169, v169
    v_lshlrev_b32 v169, 16, v171
    v_sqrt_f32 v169, v169
    s_nop 0
    v_cvt_pk_bf16_f32 v171, v169, v169
    v_lshlrev_b32 v169, 16, v171
    v_rcp_f32 v170, v169
    v_pk_add_f32 v[26:27], v[26:27], v[168:169] op_sel_hi:[1,0] neg_lo:[0,1] neg_hi:[0,1]
    v_pk_add_f32 v[28:29], v[28:29], v[168:169] op_sel_hi:[1,0] neg_lo:[0,1] neg_hi:[0,1]
    v_pk_add_f32 v[30:31], v[30:31], v[168:169] op_sel_hi:[1,0] neg_lo:[0,1] neg_hi:[0,1]
    v_pk_add_f32 v[32:33], v[32:33], v[168:169] op_sel_hi:[1,0] neg_lo:[0,1] neg_hi:[0,1]
    v_pk_add_f32 v[34:35], v[34:35], v[168:169] op_sel_hi:[1,0] neg_lo:[0,1] neg_hi:[0,1]
    v_cvt_pk_bf16_f32 v50, v26, v27
    v_cvt_pk_bf16_f32 v51, v28, v29
    v_cvt_pk_bf16_f32 v52, v30, v31
    v_cvt_pk_bf16_f32 v53, v32, v33
    v_cvt_pk_bf16_f32 v54, v34, v35
    v_lshlrev_b32 v26, 16, v50
    v_and_b32 v27, 0xffff0000, v50
    v_lshlrev_b32 v28, 16, v51
    v_and_b32 v29, 0xffff0000, v51
    v_lshlrev_b32 v30, 16, v52
    v_and_b32 v31, 0xffff0000, v52
    v_lshlrev_b32 v32, 16, v53
    v_and_b32 v33, 0xffff0000, v53
    v_lshlrev_b32 v34, 16, v54
    v_and_b32 v35, 0xffff0000, v54
    v_pk_mul_f32 v[26:27], v[26:27], v[170:171] op_sel_hi:[1,0]
    v_pk_mul_f32 v[28:29], v[28:29], v[170:171] op_sel_hi:[1,0]
    v_pk_mul_f32 v[30:31], v[30:31], v[170:171] op_sel_hi:[1,0]
    v_pk_mul_f32 v[32:33], v[32:33], v[170:171] op_sel_hi:[1,0]
    v_pk_mul_f32 v[34:35], v[34:35], v[170:171] op_sel_hi:[1,0]
    v_cvt_pk_bf16_f32 v50, v26, v27
    v_cvt_pk_bf16_f32 v51, v28, v29
    v_cvt_pk_bf16_f32 v52, v30, v31
    v_cvt_pk_bf16_f32 v53, v32, v33
    v_cvt_pk_bf16_f32 v54, v34, v35
    v_lshlrev_b32_sdwa v36, 1, v50 dst_sel:DWORD dst_unused:UNUSED_PAD src0_sel:DWORD src1_sel:WORD_0
    v_lshlrev_b32_sdwa v37, 1, v50 dst_sel:DWORD dst_unused:UNUSED_PAD src0_sel:DWORD src1_sel:WORD_1
    v_lshlrev_b32_sdwa v38, 1, v51 dst_sel:DWORD dst_unused:UNUSED_PAD src0_sel:DWORD src1_sel:WORD_0
    v_lshlrev_b32_sdwa v39, 1, v51 dst_sel:DWORD dst_unused:UNUSED_PAD src0_sel:DWORD src1_sel:WORD_1
    v_lshlrev_b32_sdwa v40, 1, v52 dst_sel:DWORD dst_unused:UNUSED_PAD src0_sel:DWORD src1_sel:WORD_0
    v_lshlrev_b32_sdwa v41, 1, v52 dst_sel:DWORD dst_unused:UNUSED_PAD src0_sel:DWORD src1_sel:WORD_1
    v_lshlrev_b32_sdwa v42, 1, v53 dst_sel:DWORD dst_unused:UNUSED_PAD src0_sel:DWORD src1_sel:WORD_0
    v_lshlrev_b32_sdwa v43, 1, v53 dst_sel:DWORD dst_unused:UNUSED_PAD src0_sel:DWORD src1_sel:WORD_1
    v_lshlrev_b32_sdwa v44, 1, v54 dst_sel:DWORD dst_unused:UNUSED_PAD src0_sel:DWORD src1_sel:WORD_0
    v_lshlrev_b32_sdwa v45, 1, v54 dst_sel:DWORD dst_unused:UNUSED_PAD src0_sel:DWORD src1_sel:WORD_1
    ds_read_u16_d16_hi v56, v36
    ds_read_u16_d16_hi v57, v37
    ds_read_u16_d16_hi v58, v38
    ds_read_u16_d16_hi v59, v39
    ds_read_u16_d16_hi v60, v40
    ds_read_u16_d16_hi v61, v41
    ds_read_u16_d16_hi v62, v42
    ds_read_u16_d16_hi v63, v43
    ds_read_u16_d16_hi v64, v44
    ds_read_u16_d16_hi v65, v45
    v_mov_b32 v173, 0x39003900
    v_mov_b32 v172, 0
    v_and_b32 v171, 0x7fff7fff, v50
    v_pk_sub_u16 v171, v171, v173
    v_or_b32 v172, v172, v171
    v_and_b32 v171, 0x7fff7fff, v51
    v_pk_sub_u16 v171, v171, v173
    v_or_b32 v172, v172, v171
    v_and_b32 v171, 0x7fff7fff, v52
    v_pk_sub_u16 v171, v171, v173
    v_or_b32 v172, v172, v171
    v_and_b32 v171, 0x7fff7fff, v53
    v_pk_sub_u16 v171, v171, v173
    v_or_b32 v172, v172, v171
    v_and_b32 v171, 0x7fff7fff, v54
    v_pk_sub_u16 v171, v171, v173
    v_or_b32 v172, v172, v171
    v_and_b32 v172, 0xf800f800, v172
    v_cmp_ne_u32 vcc, 0, v172
    s_waitcnt lgkmcnt(0)
    s_cbranch_vccz L_nofb
    s_waitcnt vmcnt(0)
    v_and_b32 v26, 0xffff, v50
    v_lshrrev_b32 v27, 16, v50
    v_and_b32 v28, 0xffff, v51
    v_lshrrev_b32 v29, 16, v51
    v_and_b32 v30, 0xffff, v52
    v_lshrrev_b32 v31, 16, v52
    v_and_b32 v32, 0xffff, v53
    v_lshrrev_b32 v33, 16, v53
    v_and_b32 v34, 0xffff, v54
    v_lshrrev_b32 v35, 16, v54
    v_and_b32 v171, 0x7fff, v26
    v_subrev_u32 v144, 14592, v171
    v_and_b32 v171, 0x7fff, v27
    v_subrev_u32 v145, 14592, v171
    v_and_b32 v171, 0x7fff, v28
    v_subrev_u32 v146, 14592, v171
    v_and_b32 v171, 0x7fff, v29
    v_subrev_u32 v147, 14592, v171
    v_and_b32 v171, 0x7fff, v30
    v_subrev_u32 v148, 14592, v171
    v_and_b32 v171, 0x7fff, v31
    v_subrev_u32 v149, 14592, v171
    v_and_b32 v171, 0x7fff, v32
    v_subrev_u32 v150, 14592, v171
    v_and_b32 v171, 0x7fff, v33
    v_subrev_u32 v151, 14592, v171
    v_and_b32 v171, 0x7fff, v34
    v_subrev_u32 v152, 14592, v171
    v_and_b32 v171, 0x7fff, v35
    v_subrev_u32 v153, 14592, v171
    s_mov_b32 s54, 0xbdd2d3e8
    s_mov_b32 s55, 0xbdd2d3e8
    s_mov_b32 s56, 1.0
    s_mov_b32 s57, 1.0
    v_mov_b32 v12, 0xc0135761
    v_mov_b32 v13, 0xc0135761
    v_and_b32 v171, 0xfffff800, v144
    v_cmp_ne_u32 vcc, 0, v171
    s_nop 0
    s_mov_b64 s[94:95], vcc
L_fb0:
    s_cmp_eq_u64 s[94:95], 0
    s_cbranch_scc1 L_fb0_d
    s_ff1_i32_b64 s61, s[94:95]
    s_bitset0_b64 s[94:95], s61
    v_readlane_b32 s50, v26, s61
    s_nop 0
    s_lshl_b32 s50, s50, 16
    s_mov_b32 s51, s50
    s_call_b64 s[62:63], L_entry
    v_readfirstlane_b32 s52, v168
    s_mov_b32 m0, s61
    s_nop 0
    v_writelane_b32 v56, s52, m0
    s_branch L_fb0
L_fb0_d:
    v_and_b32 v171, 0xfffff800, v145
    v_cmp_ne_u32 vcc, 0, v171
    s_nop 0
    s_mov_b64 s[94:95], vcc
L_fb1:
    s_cmp_eq_u64 s[94:95], 0
    s_cbranch_scc1 L_fb1_d
    s_ff1_i32_b64 s61, s[94:95]
    s_bitset0_b64 s[94:95], s61
    v_readlane_b32 s50, v27, s61
    s_nop 0
    s_lshl_b32 s50, s50, 16
    s_mov_b32 s51, s50
    s_call_b64 s[62:63], L_entry
    v_readfirstlane_b32 s52, v168
    s_mov_b32 m0, s61
    s_nop 0
    v_writelane_b32 v57, s52, m0
    s_branch L_fb1
L_fb1_d:
    v_and_b32 v171, 0xfffff800, v146
    v_cmp_ne_u32 vcc, 0, v171
    s_nop 0
    s_mov_b64 s[94:95], vcc
L_fb2:
    s_cmp_eq_u64 s[94:95], 0
    s_cbranch_scc1 L_fb2_d
    s_ff1_i32_b64 s61, s[94:95]
    s_bitset0_b64 s[94:95], s61
    v_readlane_b32 s50, v28, s61
    s_nop 0
    s_lshl_b32 s50, s50, 16
    s_mov_b32 s51, s50
    s_call_b64 s[62:63], L_entry
    v_readfirstlane_b32 s52, v168
    s_mov_b32 m0, s61
    s_nop 0
    v_writelane_b32 v58, s52, m0
    s_branch L_fb2
L_fb2_d:
    v_and_b32 v171, 0xfffff800, v147
    v_cmp_ne_u32 vcc, 0, v171
    s_nop 0
    s_mov_b64 s[94:95], vcc
L_fb3:
    s_cmp_eq_u64 s[94:95], 0
    s_cbranch_scc1 L_fb3_d
    s_ff1_i32_b64 s61, s[94:95]
    s_bitset0_b64 s[94:95], s61
    v_readlane_b32 s50, v29, s61
    s_nop 0
    s_lshl_b32 s50, s50, 16
    s_mov_b32 s51, s50
    s_call_b64 s[62:63], L_entry
    v_readfirstlane_b32 s52, v168
    s_mov_b32 m0, s61
    s_nop 0
    v_writelane_b32 v59, s52, m0
    s_branch L_fb3
L_fb3_d:
    v_and_b32 v171, 0xfffff800, v148
    v_cmp_ne_u32 vcc, 0, v171
    s_nop 0
    s_mov_b64 s[94:95], vcc
L_fb4:
    s_cmp_eq_u64 s[94:95], 0
    s_cbranch_scc1 L_fb4_d
    s_ff1_i32_b64 s61, s[94:95]
    s_bitset0_b64 s[94:95], s61
    v_readlane_b32 s50, v30, s61
    s_nop 0
    s_lshl_b32 s50, s50, 16
    s_mov_b32 s51, s50
    s_call_b64 s[62:63], L_entry
    v_readfirstlane_b32 s52, v168
    s_mov_b32 m0, s61
    s_nop 0
    v_writelane_b32 v60, s52, m0
    s_branch L_fb4
L_fb4_d:
    v_and_b32 v171, 0xfffff800, v149
    v_cmp_ne_u32 vcc, 0, v171
    s_nop 0
    s_mov_b64 s[94:95], vcc
L_fb5:
    s_cmp_eq_u64 s[94:95], 0
    s_cbranch_scc1 L_fb5_d
    s_ff1_i32_b64 s61, s[94:95]
    s_bitset0_b64 s[94:95], s61
    v_readlane_b32 s50, v31, s61
    s_nop 0
    s_lshl_b32 s50, s50, 16
    s_mov_b32 s51, s50
    s_call_b64 s[62:63], L_entry
    v_readfirstlane_b32 s52, v168
    s_mov_b32 m0, s61
    s_nop 0
    v_writelane_b32 v61, s52, m0
    s_branch L_fb5
L_fb5_d:
    v_and_b32 v171, 0xfffff800, v150
    v_cmp_ne_u32 vcc, 0, v171
    s_nop 0
    s_mov_b64 s[94:95], vcc
L_fb6:
    s_cmp_eq_u64 s[94:95], 0
    s_cbranch_scc1 L_fb6_d
    s_ff1_i32_b64 s61, s[94:95]
    s_bitset0_b64 s[94:95], s61
    v_readlane_b32 s50, v32, s61
    s_nop 0
    s_lshl_b32 s50, s50, 16
    s_mov_b32 s51, s50
    s_call_b64 s[62:63], L_entry
    v_readfirstlane_b32 s52, v168
    s_mov_b32 m0, s61
    s_nop 0
    v_writelane_b32 v62, s52, m0
    s_branch L_fb6
L_fb6_d:
    v_and_b32 v171, 0xfffff800, v151
    v_cmp_ne_u32 vcc, 0, v171
    s_nop 0
    s_mov_b64 s[94:95], vcc
L_fb7:
    s_cmp_eq_u64 s[94:95], 0
    s_cbranch_scc1 L_fb7_d
    s_ff1_i32_b64 s61, s[94:95]
    s_bitset0_b64 s[94:95], s61
    v_readlane_b32 s50, v33, s61
    s_nop 0
    s_lshl_b32 s50, s50, 16
    s_mov_b32 s51, s50
    s_call_b64 s[62:63], L_entry
    v_readfirstlane_b32 s52, v168
    s_mov_b32 m0, s61
    s_nop 0
    v_writelane_b32 v63, s52, m0
    s_branch L_fb7
L_fb7_d:
    v_and_b32 v171, 0xfffff800, v152
    v_cmp_ne_u32 vcc, 0, v171
    s_nop 0
    s_mov_b64 s[94:95], vcc
L_fb8:
    s_cmp_eq_u64 s[94:95], 0
    s_cbranch_scc1 L_fb8_d
    s_ff1_i32_b64 s61, s[94:95]
    s_bitset0_b64 s[94:95], s61
    v_readlane_b32 s50, v34, s61
    s_nop 0
    s_lshl_b32 s50, s50, 16
    s_mov_b32 s51, s50
    s_call_b64 s[62:63], L_entry
    v_readfirstlane_b32 s52, v168
    s_mov_b32 m0, s61
    s_nop 0
    v_writelane_b32 v64, s52, m0
    s_branch L_fb8
L_fb8_d:
    v_and_b32 v171, 0xfffff800, v153
    v_cmp_ne_u32 vcc, 0, v171
    s_nop 0
    s_mov_b64 s[94:95], vcc
L_fb9:
    s_cmp_eq_u64 s[94:95], 0
    s_cbranch_scc1 L_fb9_d
    s_ff1_i32_b64 s61, s[94:95]
    s_bitset0_b64 s[94:95], s61
    v_readlane_b32 s50, v35, s61
    s_nop 0
    s_lshl_b32 s50, s50, 16
    s_mov_b32 s51, s50
    s_call_b64 s[62:63], L_entry
    v_readfirstlane_b32 s52, v168
    s_mov_b32 m0, s61
    s_nop 0
    v_writelane_b32 v65, s52, m0
    s_branch L_fb9
L_fb9_d:
L_nofb:
    v_pk_add_f32 v[56:57], v[56:57], v[16:17]
    v_pk_add_f32 v[58:59], v[58:59], v[18:19]
    v_pk_add_f32 v[60:61], v[60:61], v[20:21]
    v_pk_add_f32 v[62:63], v[62:63], v[22:23]
    v_pk_add_f32 v[64:65], v[64:65], v[24:25]
    v_cvt_pk_bf16_f32 v50, v56, v57
    v_cvt_pk_bf16_f32 v51, v58, v59
    v_cvt_pk_bf16_f32 v52, v60, v61
    v_cvt_pk_bf16_f32 v53, v62, v63
    v_cvt_pk_bf16_f32 v54, v64, v65
    v_lshlrev_b32 v171, 2, v0
    global_store_dword v171, v50, s[44:45] offset:0
    global_store_dword v171, v51, s[44:45] offset:256
    global_store_dword v171, v52, s[44:45] offset:512
    global_store_dword v171, v53, s[44:45] offset:768
    global_store_dword v171, v54, s[44:45] offset:1024
L_done:
    s_endpgm
L_entry:
    v_mov_b32 v168, 0
    v_lshlrev_b32 v76, 16, v192
    v_and_b32 v77, 0xffff0000, v192
    v_lshlrev_b32 v78, 16, v204
    v_and_b32 v79, 0xffff0000, v204
    v_lshlrev_b32 v86, 16, v193
    v_and_b32 v87, 0xffff0000, v193
    v_lshlrev_b32 v88, 16, v205
    v_and_b32 v89, 0xffff0000, v205
    v_lshlrev_b32 v96, 16, v194
    v_and_b32 v97, 0xffff0000, v194
    v_lshlrev_b32 v98, 16, v206
    v_and_b32 v99, 0xffff0000, v206
    v_lshlrev_b32 v106, 16, v195
    v_and_b32 v107, 0xffff0000, v195
    v_lshlrev_b32 v108, 16, v207
    v_and_b32 v109, 0xffff0000, v207
    v_pk_mul_f32 v[72:73], v[76:77], s[50:51]
    v_pk_mul_f32 v[82:83], v[86:87], s[50:51]
    v_pk_mul_f32 v[92:93], v[96:97], s[50:51]
    v_pk_mul_f32 v[102:103], v[106:107], s[50:51]
    v_cvt_pk_bf16_f32 v80, v72, v73
    v_cvt_pk_bf16_f32 v90, v82, v83
    v_cvt_pk_bf16_f32 v100, v92, v93
    v_cvt_pk_bf16_f32 v110, v102, v103
    v_lshlrev_b32 v72, 16, v80
    v_and_b32 v73, 0xffff0000, v80
    v_lshlrev_b32 v82, 16, v90
    v_and_b32 v83, 0xffff0000, v90
    v_lshlrev_b32 v92, 16, v100
    v_and_b32 v93, 0xffff0000, v100
    v_lshlrev_b32 v102, 16, v110
    v_and_b32 v103, 0xffff0000, v110
    v_pk_add_f32 v[72:73], v[72:73], v[78:79]
    v_pk_add_f32 v[82:83], v[82:83], v[88:89]
    v_pk_add_f32 v[92:93], v[92:93], v[98:99]
    v_pk_add_f32 v[102:103], v[102:103], v[108:109]
    v_cvt_pk_bf16_f32 v80, v72, v73
    v_cvt_pk_bf16_f32 v90, v82, v83
    v_cvt_pk_bf16_f32 v100, v92, v93
    v_cvt_pk_bf16_f32 v110, v102, v103
    v_lshlrev_b32 v72, 16, v80
    v_and_b32 v73, 0xffff0000, v80
    v_lshlrev_b32 v82, 16, v90
    v_and_b32 v83, 0xffff0000, v90
    v_lshlrev_b32 v92, 16, v100
    v_and_b32 v93, 0xffff0000, v100
    v_lshlrev_b32 v102, 16, v110
    v_and_b32 v103, 0xffff0000, v110
    v_pk_mul_f32 v[74:75], v[72:73], v[72:73]
    v_pk_mul_f32 v[84:85], v[82:83], v[82:83]
    v_pk_mul_f32 v[94:95], v[92:93], v[92:93]
    v_pk_mul_f32 v[104:105], v[102:103], v[102:103]
    v_pk_fma_f32 v[74:75], v[74:75], s[54:55], v[12:13]
    v_pk_fma_f32 v[84:85], v[84:85], s[54:55], v[12:13]
    v_pk_fma_f32 v[94:95], v[94:95], s[54:55], v[12:13]
    v_pk_fma_f32 v[104:105], v[104:105], s[54:55], v[12:13]
    v_pk_mul_f32 v[74:75], v[74:75], v[72:73]
    v_pk_mul_f32 v[84:85], v[84:85], v[82:83]
    v_pk_mul_f32 v[94:95], v[94:95], v[92:93]
    v_pk_mul_f32 v[104:105], v[104:105], v[102:103]
    v_exp_f32 v74, v74
    v_exp_f32 v75, v75
    v_exp_f32 v84, v84
    v_exp_f32 v85, v85
    v_exp_f32 v94, v94
    v_exp_f32 v95, v95
    v_exp_f32 v104, v104
    v_exp_f32 v105, v105
    v_pk_add_f32 v[74:75], v[74:75], s[56:57]
    v_pk_add_f32 v[84:85], v[84:85], s[56:57]
    v_pk_add_f32 v[94:95], v[94:95], s[56:57]
    v_pk_add_f32 v[104:105], v[104:105], s[56:57]
    v_rcp_f32 v74, v74
    v_rcp_f32 v75, v75
    v_rcp_f32 v84, v84
    v_rcp_f32 v85, v85
    v_rcp_f32 v94, v94
    v_rcp_f32 v95, v95
    v_rcp_f32 v104, v104
    v_rcp_f32 v105, v105
    v_pk_mul_f32 v[74:75], v[74:75], v[72:73]
    v_pk_mul_f32 v[84:85], v[84:85], v[82:83]
    v_pk_mul_f32 v[94:95], v[94:95], v[92:93]
    v_pk_mul_f32 v[104:105], v[104:105], v[102:103]
    v_cvt_pk_bf16_f32 v80, v74, v75
    v_cvt_pk_bf16_f32 v90, v84, v85
    v_cvt_pk_bf16_f32 v100, v94, v95
    v_cvt_pk_bf16_f32 v110, v104, v105
    v_dot2c_f32_bf16 v168, v80, v216
    v_dot2c_f32_bf16 v168, v90, v217
    v_dot2c_f32_bf16 v168, v100, v218
    v_dot2c_f32_bf16 v168, v110, v219
    v_lshlrev_b32 v76, 16, v196
    v_and_b32 v77, 0xffff0000, v196
    v_lshlrev_b32 v78, 16, v208
    v_and_b32 v79, 0xffff0000, v208
    v_lshlrev_b32 v86, 16, v197
    v_and_b32 v87, 0xffff0000, v197
    v_lshlrev_b32 v88, 16, v209
    v_and_b32 v89, 0xffff0000, v209
    v_lshlrev_b32 v96, 16, v198
    v_and_b32 v97, 0xffff0000, v198
    v_lshlrev_b32 v98, 16, v210
    v_and_b32 v99, 0xffff0000, v210
    v_lshlrev_b32 v106, 16, v199
    v_and_b32 v107, 0xffff0000, v199
    v_lshlrev_b32 v108, 16, v211
    v_and_b32 v109, 0xffff0000, v211
    v_pk_mul_f32 v[72:73], v[76:77], s[50:51]
    v_pk_mul_f32 v[82:83], v[86:87], s[50:51]
    v_pk_mul_f32 v[92:93], v[96:97], s[50:51]
    v_pk_mul_f32 v[102:103], v[106:107], s[50:51]
    v_cvt_pk_bf16_f32 v80, v72, v73
    v_cvt_pk_bf16_f32 v90, v82, v83
    v_cvt_pk_bf16_f32 v100, v92, v93
    v_cvt_pk_bf16_f32 v110, v102, v103
    v_lshlrev_b32 v72, 16, v80
    v_and_b32 v73, 0xffff0000, v80
    v_lshlrev_b32 v82, 16, v90
    v_and_b32 v83, 0xffff0000, v90
    v_lshlrev_b32 v92, 16, v100
    v_and_b32 v93, 0xffff0000, v100
    v_lshlrev_b32 v102, 16, v110
    v_and_b32 v103, 0xffff0000, v110
    v_pk_add_f32 v[72:73], v[72:73], v[78:79]
    v_pk_add_f32 v[82:83], v[82:83], v[88:89]
    v_pk_add_f32 v[92:93], v[92:93], v[98:99]
    v_pk_add_f32 v[102:103], v[102:103], v[108:109]
    v_cvt_pk_bf16_f32 v80, v72, v73
    v_cvt_pk_bf16_f32 v90, v82, v83
    v_cvt_pk_bf16_f32 v100, v92, v93
    v_cvt_pk_bf16_f32 v110, v102, v103
    v_lshlrev_b32 v72, 16, v80
    v_and_b32 v73, 0xffff0000, v80
    v_lshlrev_b32 v82, 16, v90
    v_and_b32 v83, 0xffff0000, v90
    v_lshlrev_b32 v92, 16, v100
    v_and_b32 v93, 0xffff0000, v100
    v_lshlrev_b32 v102, 16, v110
    v_and_b32 v103, 0xffff0000, v110
    v_pk_mul_f32 v[74:75], v[72:73], v[72:73]
    v_pk_mul_f32 v[84:85], v[82:83], v[82:83]
    v_pk_mul_f32 v[94:95], v[92:93], v[92:93]
    v_pk_mul_f32 v[104:105], v[102:103], v[102:103]
    v_pk_fma_f32 v[74:75], v[74:75], s[54:55], v[12:13]
    v_pk_fma_f32 v[84:85], v[84:85], s[54:55], v[12:13]
    v_pk_fma_f32 v[94:95], v[94:95], s[54:55], v[12:13]
    v_pk_fma_f32 v[104:105], v[104:105], s[54:55], v[12:13]
    v_pk_mul_f32 v[74:75], v[74:75], v[72:73]
    v_pk_mul_f32 v[84:85], v[84:85], v[82:83]
    v_pk_mul_f32 v[94:95], v[94:95], v[92:93]
    v_pk_mul_f32 v[104:105], v[104:105], v[102:103]
    v_exp_f32 v74, v74
    v_exp_f32 v75, v75
    v_exp_f32 v84, v84
    v_exp_f32 v85, v85
    v_exp_f32 v94, v94
    v_exp_f32 v95, v95
    v_exp_f32 v104, v104
    v_exp_f32 v105, v105
    v_pk_add_f32 v[74:75], v[74:75], s[56:57]
    v_pk_add_f32 v[84:85], v[84:85], s[56:57]
    v_pk_add_f32 v[94:95], v[94:95], s[56:57]
    v_pk_add_f32 v[104:105], v[104:105], s[56:57]
    v_rcp_f32 v74, v74
    v_rcp_f32 v75, v75
    v_rcp_f32 v84, v84
    v_rcp_f32 v85, v85
    v_rcp_f32 v94, v94
    v_rcp_f32 v95, v95
    v_rcp_f32 v104, v104
    v_rcp_f32 v105, v105
    v_pk_mul_f32 v[74:75], v[74:75], v[72:73]
    v_pk_mul_f32 v[84:85], v[84:85], v[82:83]
    v_pk_mul_f32 v[94:95], v[94:95], v[92:93]
    v_pk_mul_f32 v[104:105], v[104:105], v[102:103]
    v_cvt_pk_bf16_f32 v80, v74, v75
    v_cvt_pk_bf16_f32 v90, v84, v85
    v_cvt_pk_bf16_f32 v100, v94, v95
    v_cvt_pk_bf16_f32 v110, v104, v105
    v_dot2c_f32_bf16 v168, v80, v220
    v_dot2c_f32_bf16 v168, v90, v221
    v_dot2c_f32_bf16 v168, v100, v222
    v_dot2c_f32_bf16 v168, v110, v223
    v_lshlrev_b32 v76, 16, v200
    v_and_b32 v77, 0xffff0000, v200
    v_lshlrev_b32 v78, 16, v212
    v_and_b32 v79, 0xffff0000, v212
    v_lshlrev_b32 v86, 16, v201
    v_and_b32 v87, 0xffff0000, v201
    v_lshlrev_b32 v88, 16, v213
    v_and_b32 v89, 0xffff0000, v213
    v_lshlrev_b32 v96, 16, v202
    v_and_b32 v97, 0xffff0000, v202
    v_lshlrev_b32 v98, 16, v214
    v_and_b32 v99, 0xffff0000, v214
    v_lshlrev_b32 v106, 16, v203
    v_and_b32 v107, 0xffff0000, v203
    v_lshlrev_b32 v108, 16, v215
    v_and_b32 v109, 0xffff0000, v215
    v_pk_mul_f32 v[72:73], v[76:77], s[50:51]
    v_pk_mul_f32 v[82:83], v[86:87], s[50:51]
    v_pk_mul_f32 v[92:93], v[96:97], s[50:51]
    v_pk_mul_f32 v[102:103], v[106:107], s[50:51]
    v_cvt_pk_bf16_f32 v80, v72, v73
    v_cvt_pk_bf16_f32 v90, v82, v83
    v_cvt_pk_bf16_f32 v100, v92, v93
    v_cvt_pk_bf16_f32 v110, v102, v103
    v_lshlrev_b32 v72, 16, v80
    v_and_b32 v73, 0xffff0000, v80
    v_lshlrev_b32 v82, 16, v90
    v_and_b32 v83, 0xffff0000, v90
    v_lshlrev_b32 v92, 16, v100
    v_and_b32 v93, 0xffff0000, v100
    v_lshlrev_b32 v102, 16, v110
    v_and_b32 v103, 0xffff0000, v110
    v_pk_add_f32 v[72:73], v[72:73], v[78:79]
    v_pk_add_f32 v[82:83], v[82:83], v[88:89]
    v_pk_add_f32 v[92:93], v[92:93], v[98:99]
    v_pk_add_f32 v[102:103], v[102:103], v[108:109]
    v_cvt_pk_bf16_f32 v80, v72, v73
    v_cvt_pk_bf16_f32 v90, v82, v83
    v_cvt_pk_bf16_f32 v100, v92, v93
    v_cvt_pk_bf16_f32 v110, v102, v103
    v_lshlrev_b32 v72, 16, v80
    v_and_b32 v73, 0xffff0000, v80
    v_lshlrev_b32 v82, 16, v90
    v_and_b32 v83, 0xffff0000, v90
    v_lshlrev_b32 v92, 16, v100
    v_and_b32 v93, 0xffff0000, v100
    v_lshlrev_b32 v102, 16, v110
    v_and_b32 v103, 0xffff0000, v110
    v_pk_mul_f32 v[74:75], v[72:73], v[72:73]
    v_pk_mul_f32 v[84:85], v[82:83], v[82:83]
    v_pk_mul_f32 v[94:95], v[92:93], v[92:93]
    v_pk_mul_f32 v[104:105], v[102:103], v[102:103]
    v_pk_fma_f32 v[74:75], v[74:75], s[54:55], v[12:13]
    v_pk_fma_f32 v[84:85], v[84:85], s[54:55], v[12:13]
    v_pk_fma_f32 v[94:95], v[94:95], s[54:55], v[12:13]
    v_pk_fma_f32 v[104:105], v[104:105], s[54:55], v[12:13]
    v_pk_mul_f32 v[74:75], v[74:75], v[72:73]
    v_pk_mul_f32 v[84:85], v[84:85], v[82:83]
    v_pk_mul_f32 v[94:95], v[94:95], v[92:93]
    v_pk_mul_f32 v[104:105], v[104:105], v[102:103]
    v_exp_f32 v74, v74
    v_exp_f32 v75, v75
    v_exp_f32 v84, v84
    v_exp_f32 v85, v85
    v_exp_f32 v94, v94
    v_exp_f32 v95, v95
    v_exp_f32 v104, v104
    v_exp_f32 v105, v105
    v_pk_add_f32 v[74:75], v[74:75], s[56:57]
    v_pk_add_f32 v[84:85], v[84:85], s[56:57]
    v_pk_add_f32 v[94:95], v[94:95], s[56:57]
    v_pk_add_f32 v[104:105], v[104:105], s[56:57]
    v_rcp_f32 v74, v74
    v_rcp_f32 v75, v75
    v_rcp_f32 v84, v84
    v_rcp_f32 v85, v85
    v_rcp_f32 v94, v94
    v_rcp_f32 v95, v95
    v_rcp_f32 v104, v104
    v_rcp_f32 v105, v105
    v_pk_mul_f32 v[74:75], v[74:75], v[72:73]
    v_pk_mul_f32 v[84:85], v[84:85], v[82:83]
    v_pk_mul_f32 v[94:95], v[94:95], v[92:93]
    v_pk_mul_f32 v[104:105], v[104:105], v[102:103]
    v_cvt_pk_bf16_f32 v80, v74, v75
    v_cvt_pk_bf16_f32 v90, v84, v85
    v_cvt_pk_bf16_f32 v100, v94, v95
    v_cvt_pk_bf16_f32 v110, v104, v105
    v_dot2c_f32_bf16 v168, v80, v224
    v_dot2c_f32_bf16 v168, v90, v225
    v_dot2c_f32_bf16 v168, v100, v226
    v_dot2c_f32_bf16 v168, v110, v227
    s_nop 2
    v_add_f32_dpp v168, v168, v168 row_ror:8 row_mask:0xf bank_mask:0xf
    s_nop 1
    v_add_f32_dpp v168, v168, v168 row_ror:4 row_mask:0xf bank_mask:0xf
    s_nop 1
    v_add_f32_dpp v168, v168, v168 row_ror:2 row_mask:0xf bank_mask:0xf
    s_nop 1
    v_add_f32_dpp v168, v168, v168 row_ror:1 row_mask:0xf bank_mask:0xf
    v_mov_b32 v169, v168
    s_nop 1
    v_permlane16_swap_b32 v168, v169
    v_add_f32 v168, v168, v169
    v_mov_b32 v169, v168
    s_nop 1
    v_permlane32_swap_b32 v168, v169
    v_add_f32 v168, v168, v169
    v_cvt_pk_bf16_f32 v169, v168, v168
    v_lshlrev_b32 v168, 16, v169
    v_add_f32 v168, v168, v230
    v_cvt_pk_bf16_f32 v169, v168, v168
    v_lshlrev_b32 v168, 16, v169
    s_setpc_b64 s[62:63]
L_end:
    s_endpgm
.section .rodata,"a"
.p2align 6
.amdhsa_kernel sequential_preLN__sliding_block_cached__mixer_token_mlp__decode_kernel
  .amdhsa_next_free_vgpr 240
  .amdhsa_next_free_sgpr 100
  .amdhsa_accum_offset 240
  .amdhsa_group_segment_fixed_size 0
  .amdhsa_kernarg_size 104
  .amdhsa_user_sgpr_count 2
  .amdhsa_user_sgpr_kernarg_segment_ptr 1
  .amdhsa_system_sgpr_workgroup_id_x 1
  .amdhsa_float_denorm_mode_32 3
  .amdhsa_float_denorm_mode_16_64 3
.end_amdhsa_kernel
```
